```python
import torch

def _softmax(x, axis=-1):
    return torch.softmax(x, dim=axis)

def _gelu(x):
    return torch.nn.functional.gelu(x, approximate='tanh')

def _silu(x):
    return torch.nn.functional.silu(x)

def _sigmoid(x):
    return torch.sigmoid(x)

def _layernorm(x, axis=-1, eps=1e-05):
    m = x.mean(dim=axis, keepdim=True)
    v = x.var(dim=axis, keepdim=True, unbiased=False)
    return (x - m) / torch.sqrt(v + eps)

def _scatter_add(tgt, idx, src, axis=0):
    return tgt.clone().index_add_(axis, idx, src)

def _segment_sum(src, seg, n):
    out = torch.zeros((n,) + src.shape[1:], dtype=src.dtype)
    return out.index_add_(0, seg, src)

def _pad(x, pw):
    flat = tuple((v for pair in reversed(pw) for v in pair))
    return torch.nn.functional.pad(x, flat)
kernel_name = 'gather_scatter__molecular_angular_painn__graph'

def setup_inputs():

    _w = lambda a: (lambda t: t.to(torch.bfloat16) if t.is_floating_point() else t)(torch.as_tensor(a))
    N, deg, D = (50000, 16, 64)
    n_rbf = max(0, 4)
    E = N * deg
    cutoff = 5.0
    freqs = (torch.arange(1, n_rbf + 1) * torch.pi / cutoff).to(float)
    return {'sv': _w((lambda *s: torch.randn(*s, dtype=torch.bfloat16) * 0.4)(N, 4, D) * 0.3), 'pos': _w((lambda *s: torch.randn(*s, dtype=torch.bfloat16) * 3.2)(N, 3) * 1.2), 'src': _w((lambda lo, hi, *s: torch.randint(lo, hi, s))(0, N, E).to(torch.int64)), 'dst': _w((lambda lo, hi, *s: torch.randint(lo, hi, s))(0, N, E).to(torch.int64)), 'freqs': _w(freqs), 'w_phi1': _w((lambda *s: torch.randn(*s, dtype=torch.bfloat16) * 3.2)(D, D) / D ** 0.5), 'w_phi2': _w((lambda *s: torch.randn(*s, dtype=torch.bfloat16) * 3.2)(D, 3 * D) / D ** 0.5), 'w_rbf': _w((lambda *s: torch.randn(*s, dtype=torch.bfloat16) * 3.2)(n_rbf, 3 * D) / n_rbf ** 0.5)}

def reference(sv, pos, src, dst, freqs, w_phi1, w_phi2, w_rbf):
    N, _, D = sv.shape
    E = src.shape[0]
    PI, cutoff = (3.141592653589793, 5.0)
    s, v = (sv[:, 0, :].clone(), sv[:, 1:, :].clone())
    r_vec = pos[src] - pos[dst]
    d = torch.sqrt((r_vec * r_vec).sum(-1) + 1e-08)
    r_hat = r_vec / d[:, None]
    rbf = torch.sin(d[:, None] * freqs[None, :]) / d[:, None]
    fcut = 0.5 * (torch.cos(PI * d / cutoff) + 1.0)
    fcut = torch.where(d < cutoff, fcut, 0.0 * d)
    Wf = rbf @ w_rbf * fcut[:, None]
    phi = (_silu(s @ w_phi1) @ w_phi2)[src]
    m = phi * Wf
    m_s, m_vv, m_vr = (m[:, :D].clone(), m[:, D:2 * D].clone(), m[:, 2 * D:].clone())
    ds = _segment_sum(m_s, dst, N)
    dv_e = m_vv[:, None, :] * v[src] + m_vr[:, None, :] * r_hat[:, :, None]
    dv = _segment_sum(dv_e.reshape(E, 3 * D), dst, N).reshape(N, 3, D)
    return sv + torch.concatenate([ds[:, None, :], dv], axis=1)
```

```asm
; @launch kernel=painn_bin_kernel grid=(256,1,1) block=(1024,1,1) lds=154624
; @launch kernel=painn_msg_kernel grid=(256,1,1) block=(768,1,1) lds=154112
.amdgcn_target "amdgcn-amd-amdhsa--gfx950"
.text
.globl painn_bin_kernel
.p2align 8
.type painn_bin_kernel,@function
painn_bin_kernel:
    s_cmp_gt_u32 s2, 255
    s_cbranch_scc1 K1_END
    s_load_dwordx16 s[64:79], s[0:1], 0
    s_load_dwordx2 s[10:11], s[0:1], 80
    v_lshrrev_b32 v1, 6, v0
    v_and_b32 v2, 63, v0
    v_readfirstlane_b32 s44, v1
    v_lshlrev_b32 v3, 4, v2
    s_cmp_ge_u32 s2, 196
    s_cbranch_scc1 K1_NODE
    v_lshlrev_b32 v1, 4, v0
    v_and_b32 v4, 255, v0
    v_lshlrev_b32 v4, 2, v4
    v_add_u32 v4, 152576, v4
    v_mov_b32 v5, 0
    ds_write_b32 v4, v5
    s_mul_i32 s3, s2, 16384
    s_sub_u32 s45, 3200000, s3
    s_min_u32 s45, s45, 16384
    v_cmp_gt_u32 vcc, s45, v1
    s_mov_b64 s[46:47], vcc
    s_waitcnt lgkmcnt(0)
    s_add_u32 s12, s68, s3
    s_addc_u32 s13, s69, 0
    s_mov_b32 s14, s45
    s_mov_b32 s15, 0x20000
    s_add_u32 s16, s70, s3
    s_addc_u32 s17, s71, 0
    s_mov_b32 s18, s45
    s_mov_b32 s19, 0x20000
    s_mov_b32 s20, s66
    s_mov_b32 s21, s67
    s_mov_b32 s22, 300000
    s_mov_b32 s23, 0x20000
    s_mov_b64 s[90:91], s[64:65]
    s_lshr_b32 s3, s2, 3
    s_min_u32 s3, s3, 23
    s_mul_i32 s3, s3, 12544
    v_lshlrev_b32 v119, 7, v0
    v_cmp_gt_u32 vcc, 98, v0
    s_mov_b64 exec, vcc
    buffer_load_dword v123, v119, s[20:23], s3 offen
    s_mov_b64 exec, -1
    buffer_load_dwordx4 v[4:7], v1, s[12:15], 0 offen
    buffer_load_dwordx4 v[10:13], v1, s[16:19], 0 offen
    s_mul_i32 s3, s2, 49152
    s_add_u32 s3, s3, 393216
    s_add_u32 s24, s10, s3
    s_addc_u32 s25, s11, 0
    s_mov_b32 s26, 49152
    s_mov_b32 s27, 0x20000
    s_lshl_b32 s3, s2, 10
    s_add_u32 s3, s3, 65536
    s_add_u32 s28, s10, s3
    s_addc_u32 s29, s11, 0
    s_mov_b32 s30, 1024
    s_mov_b32 s31, 0x20000
    s_waitcnt vmcnt(0)
    s_cmp_lt_u32 s44, 5
    s_cselect_b64 exec, -1, 0
    s_lshl_b32 s3, s44, 10
    s_add_u32 m0, s3, 147456
    s_add_u32 s3, s3, 294912
    buffer_load_dwordx4 v3, s[20:23], s3 offen lds
    s_mov_b64 exec, -1
    s_lshl_b32 s3, s44, 10
    s_add_u32 m0, s3, 0
    s_add_u32 s3, s3, 0
    buffer_load_dwordx4 v3, s[20:23], s3 offen lds
    s_add_u32 m0, m0, 16384
    s_add_u32 s3, s3, 16384
    buffer_load_dwordx4 v3, s[20:23], s3 offen lds
    s_add_u32 m0, m0, 16384
    s_add_u32 s3, s3, 16384
    buffer_load_dwordx4 v3, s[20:23], s3 offen lds
    v_mov_b32 v119, 24575
    v_mov_b32 v120, 98303
    v_mov_b32 v121, 49151
    v_mul_u32_u24 v40, 6, v4
    v_cmp_lt_u32 s[32:33], v119, v4
    v_and_b32 v40, -4, v40
    v_subrev_u32 v118, 147456, v40
    v_min_u32 v40, v40, v118
    v_cmp_lt_u32 s[36:37], v120, v40
    v_cmp_lt_u32 vcc, v121, v40
    s_andn2_b64 s[34:35], vcc, s[36:37]
    v_mul_u32_u24 v41, 6, v5
    v_cmp_lt_u32 s[38:39], v119, v5
    v_and_b32 v41, -4, v41
    v_subrev_u32 v118, 147456, v41
    v_min_u32 v41, v41, v118
    v_cmp_lt_u32 s[42:43], v120, v41
    v_cmp_lt_u32 vcc, v121, v41
    s_andn2_b64 s[40:41], vcc, s[42:43]
    v_mul_u32_u24 v42, 6, v6
    v_cmp_lt_u32 s[50:51], v119, v6
    v_and_b32 v42, -4, v42
    v_subrev_u32 v118, 147456, v42
    v_min_u32 v42, v42, v118
    v_cmp_lt_u32 s[54:55], v120, v42
    v_cmp_lt_u32 vcc, v121, v42
    s_andn2_b64 s[52:53], vcc, s[54:55]
    v_mul_u32_u24 v43, 6, v7
    v_cmp_lt_u32 s[56:57], v119, v7
    v_and_b32 v43, -4, v43
    v_subrev_u32 v118, 147456, v43
    v_min_u32 v43, v43, v118
    v_cmp_lt_u32 s[60:61], v120, v43
    v_cmp_lt_u32 vcc, v121, v43
    s_andn2_b64 s[58:59], vcc, s[60:61]
    v_mul_u32_u24 v44, 6, v10
    v_cmp_lt_u32 s[62:63], v119, v10
    v_and_b32 v44, -4, v44
    v_subrev_u32 v118, 147456, v44
    v_min_u32 v44, v44, v118
    v_cmp_lt_u32 s[66:67], v120, v44
    v_cmp_lt_u32 vcc, v121, v44
    s_andn2_b64 s[64:65], vcc, s[66:67]
    v_mul_u32_u24 v45, 6, v11
    v_cmp_lt_u32 s[68:69], v119, v11
    v_and_b32 v45, -4, v45
    v_subrev_u32 v118, 147456, v45
    v_min_u32 v45, v45, v118
    v_cmp_lt_u32 s[72:73], v120, v45
    v_cmp_lt_u32 vcc, v121, v45
    s_andn2_b64 s[70:71], vcc, s[72:73]
    v_mul_u32_u24 v46, 6, v12
    v_cmp_lt_u32 s[74:75], v119, v12
    v_and_b32 v46, -4, v46
    v_subrev_u32 v118, 147456, v46
    v_min_u32 v46, v46, v118
    v_cmp_lt_u32 s[78:79], v120, v46
    v_cmp_lt_u32 vcc, v121, v46
    s_andn2_b64 s[76:77], vcc, s[78:79]
    v_mul_u32_u24 v47, 6, v13
    v_cmp_lt_u32 s[80:81], v119, v13
    v_and_b32 v47, -4, v47
    v_subrev_u32 v118, 147456, v47
    v_min_u32 v47, v47, v118
    v_cmp_lt_u32 s[84:85], v120, v47
    v_cmp_lt_u32 vcc, v121, v47
    s_andn2_b64 s[82:83], vcc, s[84:85]
    s_lshl_b32 s3, s44, 10
    s_add_u32 m0, s3, 49152
    s_add_u32 s3, s3, 49152
    buffer_load_dwordx4 v3, s[20:23], s3 offen lds
    s_add_u32 m0, m0, 16384
    s_add_u32 s3, s3, 16384
    buffer_load_dwordx4 v3, s[20:23], s3 offen lds
    s_add_u32 m0, m0, 16384
    s_add_u32 s3, s3, 16384
    buffer_load_dwordx4 v3, s[20:23], s3 offen lds
    s_waitcnt vmcnt(3) lgkmcnt(0)
    s_barrier
    s_or_b64 vcc, s[34:35], s[36:37]
    s_nor_b64 exec, vcc, s[32:33]
    ds_read2_b32 v[16:17], v40 offset1:1
    s_or_b64 vcc, s[40:41], s[42:43]
    s_nor_b64 exec, vcc, s[38:39]
    ds_read2_b32 v[18:19], v41 offset1:1
    s_or_b64 vcc, s[52:53], s[54:55]
    s_nor_b64 exec, vcc, s[50:51]
    ds_read2_b32 v[20:21], v42 offset1:1
    s_or_b64 vcc, s[58:59], s[60:61]
    s_nor_b64 exec, vcc, s[56:57]
    ds_read2_b32 v[22:23], v43 offset1:1
    s_or_b64 vcc, s[64:65], s[66:67]
    s_nor_b64 exec, vcc, s[62:63]
    ds_read2_b32 v[24:25], v44 offset1:1
    s_or_b64 vcc, s[70:71], s[72:73]
    s_nor_b64 exec, vcc, s[68:69]
    ds_read2_b32 v[26:27], v45 offset1:1
    s_or_b64 vcc, s[76:77], s[78:79]
    s_nor_b64 exec, vcc, s[74:75]
    ds_read2_b32 v[28:29], v46 offset1:1
    s_or_b64 vcc, s[82:83], s[84:85]
    s_nor_b64 exec, vcc, s[80:81]
    ds_read2_b32 v[30:31], v47 offset1:1
    s_mov_b64 exec, -1
    s_lshl_b32 s3, s44, 10
    s_add_u32 m0, s3, 98304
    s_add_u32 s3, s3, 98304
    buffer_load_dwordx4 v3, s[20:23], s3 offen lds
    s_add_u32 m0, m0, 16384
    s_add_u32 s3, s3, 16384
    buffer_load_dwordx4 v3, s[20:23], s3 offen lds
    s_add_u32 m0, m0, 16384
    s_add_u32 s3, s3, 16384
    buffer_load_dwordx4 v3, s[20:23], s3 offen lds
    v_bfe_i32 v118, v4, 0, 1
    v_and_b32 v118, 0x02020000, v118
    v_add_u32 v52, 0x01000c0c, v118
    v_add_u32 v53, 0x03020c0c, v118
    v_add_u32 v54, 0x05040c0c, v118
    v_bfe_i32 v118, v5, 0, 1
    v_and_b32 v118, 0x02020000, v118
    v_add_u32 v55, 0x01000c0c, v118
    v_add_u32 v56, 0x03020c0c, v118
    v_add_u32 v57, 0x05040c0c, v118
    v_bfe_i32 v118, v6, 0, 1
    v_and_b32 v118, 0x02020000, v118
    v_add_u32 v58, 0x01000c0c, v118
    v_add_u32 v59, 0x03020c0c, v118
    v_add_u32 v60, 0x05040c0c, v118
    s_waitcnt vmcnt(3) lgkmcnt(0)
    s_barrier
    s_andn2_b64 exec, s[34:35], s[32:33]
    ds_read2_b32 v[16:17], v40 offset1:1
    s_andn2_b64 exec, s[40:41], s[38:39]
    ds_read2_b32 v[18:19], v41 offset1:1
    s_andn2_b64 exec, s[52:53], s[50:51]
    ds_read2_b32 v[20:21], v42 offset1:1
    s_andn2_b64 exec, s[58:59], s[56:57]
    ds_read2_b32 v[22:23], v43 offset1:1
    s_andn2_b64 exec, s[64:65], s[62:63]
    ds_read2_b32 v[24:25], v44 offset1:1
    s_andn2_b64 exec, s[70:71], s[68:69]
    ds_read2_b32 v[26:27], v45 offset1:1
    s_andn2_b64 exec, s[76:77], s[74:75]
    ds_read2_b32 v[28:29], v46 offset1:1
    s_andn2_b64 exec, s[82:83], s[80:81]
    ds_read2_b32 v[30:31], v47 offset1:1
    s_mov_b64 exec, -1
    s_lshl_b32 s3, s44, 10
    s_add_u32 m0, s3, 0
    s_add_u32 s3, s3, 147456
    buffer_load_dwordx4 v3, s[20:23], s3 offen lds
    s_add_u32 m0, m0, 16384
    s_add_u32 s3, s3, 16384
    buffer_load_dwordx4 v3, s[20:23], s3 offen lds
    s_add_u32 m0, m0, 16384
    s_add_u32 s3, s3, 16384
    buffer_load_dwordx4 v3, s[20:23], s3 offen lds
    v_bfe_i32 v118, v7, 0, 1
    v_and_b32 v118, 0x02020000, v118
    v_add_u32 v61, 0x01000c0c, v118
    v_add_u32 v62, 0x03020c0c, v118
    v_add_u32 v63, 0x05040c0c, v118
    v_bfe_i32 v118, v10, 0, 1
    v_and_b32 v118, 0x02020000, v118
    v_add_u32 v64, 0x01000c0c, v118
    v_add_u32 v65, 0x03020c0c, v118
    v_add_u32 v66, 0x05040c0c, v118
    v_bfe_i32 v118, v11, 0, 1
    v_and_b32 v118, 0x02020000, v118
    v_add_u32 v67, 0x01000c0c, v118
    v_add_u32 v68, 0x03020c0c, v118
    v_add_u32 v69, 0x05040c0c, v118
    s_waitcnt vmcnt(3) lgkmcnt(0)
    s_barrier
    s_andn2_b64 exec, s[36:37], s[32:33]
    ds_read2_b32 v[16:17], v40 offset1:1
    s_andn2_b64 exec, s[42:43], s[38:39]
    ds_read2_b32 v[18:19], v41 offset1:1
    s_andn2_b64 exec, s[54:55], s[50:51]
    ds_read2_b32 v[20:21], v42 offset1:1
    s_andn2_b64 exec, s[60:61], s[56:57]
    ds_read2_b32 v[22:23], v43 offset1:1
    s_andn2_b64 exec, s[66:67], s[62:63]
    ds_read2_b32 v[24:25], v44 offset1:1
    s_andn2_b64 exec, s[72:73], s[68:69]
    ds_read2_b32 v[26:27], v45 offset1:1
    s_andn2_b64 exec, s[78:79], s[74:75]
    ds_read2_b32 v[28:29], v46 offset1:1
    s_andn2_b64 exec, s[84:85], s[80:81]
    ds_read2_b32 v[30:31], v47 offset1:1
    s_mov_b64 exec, -1
    s_lshl_b32 s3, s44, 10
    s_add_u32 m0, s3, 49152
    s_add_u32 s3, s3, 196608
    buffer_load_dwordx4 v3, s[20:23], s3 offen lds
    s_add_u32 m0, m0, 16384
    s_add_u32 s3, s3, 16384
    buffer_load_dwordx4 v3, s[20:23], s3 offen lds
    s_add_u32 m0, m0, 16384
    s_add_u32 s3, s3, 16384
    buffer_load_dwordx4 v3, s[20:23], s3 offen lds
    v_bfe_i32 v118, v12, 0, 1
    v_and_b32 v118, 0x02020000, v118
    v_add_u32 v70, 0x01000c0c, v118
    v_add_u32 v71, 0x03020c0c, v118
    v_add_u32 v72, 0x05040c0c, v118
    v_bfe_i32 v118, v13, 0, 1
    v_and_b32 v118, 0x02020000, v118
    v_add_u32 v73, 0x01000c0c, v118
    v_add_u32 v74, 0x03020c0c, v118
    v_add_u32 v75, 0x05040c0c, v118
    s_waitcnt vmcnt(3) lgkmcnt(0)
    s_barrier
    s_or_b64 vcc, s[34:35], s[36:37]
    s_andn2_b64 exec, s[32:33], vcc
    ds_read2_b32 v[16:17], v40 offset1:1
    s_or_b64 vcc, s[40:41], s[42:43]
    s_andn2_b64 exec, s[38:39], vcc
    ds_read2_b32 v[18:19], v41 offset1:1
    s_or_b64 vcc, s[52:53], s[54:55]
    s_andn2_b64 exec, s[50:51], vcc
    ds_read2_b32 v[20:21], v42 offset1:1
    s_or_b64 vcc, s[58:59], s[60:61]
    s_andn2_b64 exec, s[56:57], vcc
    ds_read2_b32 v[22:23], v43 offset1:1
    s_or_b64 vcc, s[64:65], s[66:67]
    s_andn2_b64 exec, s[62:63], vcc
    ds_read2_b32 v[24:25], v44 offset1:1
    s_or_b64 vcc, s[70:71], s[72:73]
    s_andn2_b64 exec, s[68:69], vcc
    ds_read2_b32 v[26:27], v45 offset1:1
    s_or_b64 vcc, s[76:77], s[78:79]
    s_andn2_b64 exec, s[74:75], vcc
    ds_read2_b32 v[28:29], v46 offset1:1
    s_or_b64 vcc, s[82:83], s[84:85]
    s_andn2_b64 exec, s[80:81], vcc
    ds_read2_b32 v[30:31], v47 offset1:1
    s_mov_b64 exec, -1
    s_lshl_b32 s3, s44, 10
    s_add_u32 m0, s3, 98304
    s_add_u32 s3, s3, 245760
    buffer_load_dwordx4 v3, s[20:23], s3 offen lds
    s_add_u32 m0, m0, 16384
    s_add_u32 s3, s3, 16384
    buffer_load_dwordx4 v3, s[20:23], s3 offen lds
    s_add_u32 m0, m0, 16384
    s_add_u32 s3, s3, 16384
    buffer_load_dwordx4 v3, s[20:23], s3 offen lds
    s_waitcnt vmcnt(3) lgkmcnt(0)
    s_barrier
    s_and_b64 exec, s[34:35], s[32:33]
    ds_read2_b32 v[16:17], v40 offset1:1
    s_and_b64 exec, s[40:41], s[38:39]
    ds_read2_b32 v[18:19], v41 offset1:1
    s_and_b64 exec, s[52:53], s[50:51]
    ds_read2_b32 v[20:21], v42 offset1:1
    s_and_b64 exec, s[58:59], s[56:57]
    ds_read2_b32 v[22:23], v43 offset1:1
    s_and_b64 exec, s[64:65], s[62:63]
    ds_read2_b32 v[24:25], v44 offset1:1
    s_and_b64 exec, s[70:71], s[68:69]
    ds_read2_b32 v[26:27], v45 offset1:1
    s_and_b64 exec, s[76:77], s[74:75]
    ds_read2_b32 v[28:29], v46 offset1:1
    s_and_b64 exec, s[82:83], s[80:81]
    ds_read2_b32 v[30:31], v47 offset1:1
    s_mov_b64 exec, -1
    s_and_b32 s3, s2, 7
    s_mul_i32 s3, s3, 6272
    s_lshr_b32 s45, s2, 3
    s_lshl_b32 s45, s45, 8
    s_add_u32 s3, s3, s45
    s_min_u32 s3, s3, 50000
    s_lshl_b32 s3, s3, 9
    s_sub_u32 s45, 25600000, s3
    s_add_u32 s12, s90, s3
    s_addc_u32 s13, s91, 0
    s_mov_b32 s14, s45
    s_mov_b32 s15, 0x20000
    s_lshl_b32 s3, s44, 13
    v_lshlrev_b32 v119, 7, v2
    s_mov_b32 exec_lo, 0x22222222
    s_mov_b32 exec_hi, 0x22222222
    buffer_load_dword v123, v119, s[12:15], s3 offen
    s_mov_b64 exec, -1
    v_mov_b32 v122, 1
    v_mul_u32_u24 v112, 85599, v10
    v_lshl_or_b32 v88, v10, 16, v4
    v_lshrrev_b32 v112, 22, v112
    v_and_b32 v112, -4, v112
    v_add_u32 v112, 152576, v112
    v_mul_u32_u24 v113, 85599, v11
    v_lshl_or_b32 v92, v11, 16, v5
    v_lshrrev_b32 v113, 22, v113
    v_and_b32 v113, -4, v113
    v_add_u32 v113, 152576, v113
    v_mul_u32_u24 v114, 85599, v12
    v_lshl_or_b32 v96, v12, 16, v6
    v_lshrrev_b32 v114, 22, v114
    v_and_b32 v114, -4, v114
    v_add_u32 v114, 152576, v114
    v_mul_u32_u24 v115, 85599, v13
    v_lshl_or_b32 v100, v13, 16, v7
    v_lshrrev_b32 v115, 22, v115
    v_and_b32 v115, -4, v115
    v_add_u32 v115, 152576, v115
    s_waitcnt vmcnt(1) lgkmcnt(0)
    s_barrier
    s_and_b64 exec, s[36:37], s[32:33]
    ds_read2_b32 v[16:17], v40 offset1:1
    s_and_b64 exec, s[42:43], s[38:39]
    ds_read2_b32 v[18:19], v41 offset1:1
    s_and_b64 exec, s[54:55], s[50:51]
    ds_read2_b32 v[20:21], v42 offset1:1
    s_and_b64 exec, s[60:61], s[56:57]
    ds_read2_b32 v[22:23], v43 offset1:1
    s_and_b64 exec, s[66:67], s[62:63]
    ds_read2_b32 v[24:25], v44 offset1:1
    s_and_b64 exec, s[72:73], s[68:69]
    ds_read2_b32 v[26:27], v45 offset1:1
    s_and_b64 exec, s[78:79], s[74:75]
    ds_read2_b32 v[28:29], v46 offset1:1
    s_and_b64 exec, s[84:85], s[80:81]
    ds_read2_b32 v[30:31], v47 offset1:1
    s_mov_b64 exec, -1
    s_waitcnt lgkmcnt(0)
    v_perm_b32 v52, v17, v16, v52
    v_perm_b32 v64, v25, v24, v64
    v_perm_b32 v53, v17, v16, v53
    v_perm_b32 v65, v25, v24, v65
    v_perm_b32 v54, v17, v16, v54
    v_perm_b32 v66, v25, v24, v66
    v_sub_f32 v118, v52, v64
    v_sub_f32 v119, v53, v65
    v_sub_f32 v120, v54, v66
    v_mul_f32 v121, v118, v118
    v_fmac_f32 v121, v119, v119
    v_fmac_f32 v121, v120, v120
    v_subrev_u32 v121, 0x41c20000, v121
    v_cmp_le_u32 vcc, 0x3dbe0000, v121
    v_cvt_pk_bf16_f32 v89, v118, v119
    v_cvt_pk_bf16_f32 v90, v120, v120
    s_and_b64 s[50:51], vcc, s[46:47]
    s_mov_b64 exec, s[50:51]
    ds_add_rtn_u32 v91, v112, v122
    s_mov_b64 exec, -1
    v_perm_b32 v55, v19, v18, v55
    v_perm_b32 v67, v27, v26, v67
    v_perm_b32 v56, v19, v18, v56
    v_perm_b32 v68, v27, v26, v68
    v_perm_b32 v57, v19, v18, v57
    v_perm_b32 v69, v27, v26, v69
    v_sub_f32 v118, v55, v67
    v_sub_f32 v119, v56, v68
    v_sub_f32 v120, v57, v69
    v_mul_f32 v121, v118, v118
    v_fmac_f32 v121, v119, v119
    v_fmac_f32 v121, v120, v120
    v_subrev_u32 v121, 0x41c20000, v121
    v_cmp_le_u32 vcc, 0x3dbe0000, v121
    v_cvt_pk_bf16_f32 v93, v118, v119
    v_cvt_pk_bf16_f32 v94, v120, v120
    s_and_b64 s[52:53], vcc, s[46:47]
    s_mov_b64 exec, s[52:53]
    ds_add_rtn_u32 v95, v113, v122
    s_mov_b64 exec, -1
    v_perm_b32 v58, v21, v20, v58
    v_perm_b32 v70, v29, v28, v70
    v_perm_b32 v59, v21, v20, v59
    v_perm_b32 v71, v29, v28, v71
    v_perm_b32 v60, v21, v20, v60
    v_perm_b32 v72, v29, v28, v72
    v_sub_f32 v118, v58, v70
    v_sub_f32 v119, v59, v71
    v_sub_f32 v120, v60, v72
    v_mul_f32 v121, v118, v118
    v_fmac_f32 v121, v119, v119
    v_fmac_f32 v121, v120, v120
    v_subrev_u32 v121, 0x41c20000, v121
    v_cmp_le_u32 vcc, 0x3dbe0000, v121
    v_cvt_pk_bf16_f32 v97, v118, v119
    v_cvt_pk_bf16_f32 v98, v120, v120
    s_and_b64 s[54:55], vcc, s[46:47]
    s_mov_b64 exec, s[54:55]
    ds_add_rtn_u32 v99, v114, v122
    s_mov_b64 exec, -1
    v_perm_b32 v61, v23, v22, v61
    v_perm_b32 v73, v31, v30, v73
    v_perm_b32 v62, v23, v22, v62
    v_perm_b32 v74, v31, v30, v74
    v_perm_b32 v63, v23, v22, v63
    v_perm_b32 v75, v31, v30, v75
    v_sub_f32 v118, v61, v73
    v_sub_f32 v119, v62, v74
    v_sub_f32 v120, v63, v75
    v_mul_f32 v121, v118, v118
    v_fmac_f32 v121, v119, v119
    v_fmac_f32 v121, v120, v120
    v_subrev_u32 v121, 0x41c20000, v121
    v_cmp_le_u32 vcc, 0x3dbe0000, v121
    v_cvt_pk_bf16_f32 v101, v118, v119
    v_cvt_pk_bf16_f32 v102, v120, v120
    s_and_b64 s[56:57], vcc, s[46:47]
    s_mov_b64 exec, s[56:57]
    ds_add_rtn_u32 v103, v115, v122
    s_mov_b64 exec, -1
    s_waitcnt lgkmcnt(0)
    s_barrier
    v_add_u32 v1, 152576, v3
    ds_read_b128 v[4:7], v1
    s_waitcnt lgkmcnt(0)
    v_add_u32 v9, v4, v5
    v_add_u32 v10, v9, v6
    v_add_u32 v11, v10, v7
    v_mov_b32 v12, v11
    s_nop 1
    v_add_u32_dpp v12, v12, v12 row_shr:1 row_mask:0xf bank_mask:0xf
    s_nop 1
    v_add_u32_dpp v12, v12, v12 row_shr:2 row_mask:0xf bank_mask:0xf
    s_nop 1
    v_add_u32_dpp v12, v12, v12 row_shr:4 row_mask:0xf bank_mask:0xf
    s_nop 1
    v_add_u32_dpp v12, v12, v12 row_shr:8 row_mask:0xf bank_mask:0xf
    s_nop 1
    v_add_u32_dpp v12, v12, v12 row_bcast:15 row_mask:0xa bank_mask:0xf
    s_nop 1
    v_add_u32_dpp v12, v12, v12 row_bcast:31 row_mask:0xc bank_mask:0xf
    s_nop 0
    v_readlane_b32 s45, v12, 63
    v_sub_u32 v12, v12, v11
    v_add_u32 v13, v12, v4
    v_add_u32 v14, v12, v9
    v_add_u32 v15, v12, v10
    ds_write_b128 v1, v[12:15] offset:1024
    ds_read_b32 v16, v112 offset:1024
    ds_read_b32 v17, v113 offset:1024
    ds_read_b32 v18, v114 offset:1024
    ds_read_b32 v19, v115 offset:1024
    s_cmp_lg_u32 s44, 0
    s_cbranch_scc1 K1_NOOFF
    v_lshl_or_b32 v4, v4, 16, v12
    v_lshl_or_b32 v5, v5, 16, v13
    v_lshl_or_b32 v6, v6, 16, v14
    v_lshl_or_b32 v7, v7, 16, v15
    buffer_store_dwordx4 v[4:7], v3, s[28:31], 0 offen
K1_NOOFF:
    s_waitcnt lgkmcnt(0)
    v_add_u32 v16, v16, v91
    v_mul_u32_u24 v16, 12, v16
    s_mov_b64 exec, s[50:51]
    buffer_store_dwordx3 v[88:90], v16, s[24:27], 0 offen
    s_mov_b64 exec, -1
    v_add_u32 v17, v17, v95
    v_mul_u32_u24 v17, 12, v17
    s_mov_b64 exec, s[52:53]
    buffer_store_dwordx3 v[92:94], v17, s[24:27], 0 offen
    s_mov_b64 exec, -1
    v_add_u32 v18, v18, v99
    v_mul_u32_u24 v18, 12, v18
    s_mov_b64 exec, s[54:55]
    buffer_store_dwordx3 v[96:98], v18, s[24:27], 0 offen
    s_mov_b64 exec, -1
    v_add_u32 v19, v19, v103
    v_mul_u32_u24 v19, 12, v19
    s_mov_b64 exec, s[56:57]
    buffer_store_dwordx3 v[100:102], v19, s[24:27], 0 offen
    s_mov_b64 exec, -1
    s_endpgm
K1_NODE:
    s_cmp_eq_u32 s2, 255
    s_cbranch_scc1 K1_PREP
    s_and_b32 s3, s2, 7
    s_sub_i32 s45, s3, 4
    s_max_i32 s45, s45, 0
    s_min_i32 s45, s45, 3
    s_mul_i32 s3, s3, 7
    s_add_u32 s3, s3, s45
    s_sub_u32 s45, s2, 196
    s_lshr_b32 s45, s45, 3
    s_add_u32 s3, s3, s45
    s_mul_i32 s3, s3, 848
    s_sub_u32 s45, 50000, s3
    s_min_u32 s45, s45, 848
    s_lshl_b32 s45, s45, 9
    s_lshl_b32 s3, s3, 9
    v_and_b32 v4, 7, v2
    v_lshrrev_b32 v5, 4, v2
    v_xor_b32 v4, v4, v5
    v_lshlrev_b32 v4, 4, v4
    v_lshrrev_b32 v6, 3, v2
    v_lshl_add_u32 v8, v6, 9, v4
    v_xor_b32 v9, 64, v8
    v_add_u32 v9, 4096, v9
    v_lshl_add_u32 v14, v6, 7, v4
    v_xor_b32 v15, 64, v14
    v_lshlrev_b32 v13, 7, v2
    v_bfe_u32 v7, v2, 4, 1
    v_lshlrev_b32 v7, 5, v7
    v_xor_b32 v7, v7, v3
    v_xor_b32 v56, 64, v7
    s_waitcnt lgkmcnt(0)
    s_add_u32 s12, s64, s3
    s_addc_u32 s13, s65, 0
    s_mov_b32 s14, s45
    s_mov_b32 s15, 0x20000
    s_lshr_b32 s3, s3, 2
    s_lshr_b32 s45, s45, 2
    s_add_u32 s3, s3, 33554432
    s_add_u32 s16, s10, s3
    s_addc_u32 s17, s11, 0
    s_mov_b32 s18, s45
    s_mov_b32 s19, 0x20000
    s_mov_b32 s20, s74
    s_mov_b32 s21, s75
    s_mov_b32 s22, 8192
    s_mov_b32 s23, 0x20000
    s_cmp_ge_u32 s44, 2
    s_cbranch_scc1 K1_NOW1
    s_mul_i32 s3, s44, 4096
    s_mov_b32 m0, s3
    s_nop 0
    buffer_load_dwordx4 v7, s[20:23], s3 offen offset:0 lds
    buffer_load_dwordx4 v56, s[20:23], s3 offen offset:1024 lds
    buffer_load_dwordx4 v7, s[20:23], s3 offen offset:2048 lds
    buffer_load_dwordx4 v56, s[20:23], s3 offen offset:3072 lds
K1_NOW1:
    s_lshl_b32 s46, s44, 11
    s_add_u32 s46, s46, 8192
    s_lshl_b32 s47, s44, 13
    s_add_u32 m0, s46, 0
    s_add_u32 s3, s47, 0
    buffer_load_dwordx4 v8, s[12:15], s3 offen lds
    s_add_u32 m0, m0, 1024
    s_nop 0
    buffer_load_dwordx4 v9, s[12:15], s3 offen lds
    s_add_u32 m0, s46, 32768
    s_add_u32 s3, s47, 131072
    buffer_load_dwordx4 v8, s[12:15], s3 offen lds
    s_add_u32 m0, m0, 1024
    s_nop 0
    buffer_load_dwordx4 v9, s[12:15], s3 offen lds
    v_bfe_u32 v4, v2, 1, 3
    v_xor_b32 v4, v4, v5
    v_and_b32 v6, 15, v2
    v_lshlrev_b32 v6, 7, v6
    v_lshl_add_u32 v4, v4, 4, v6
    v_add_u32 v10, s46, v4
    v_add_u32 v12, s46, v3
    v_bfe_u32 v57, v2, 2, 2
    v_lshl_add_u32 v58, v5, 3, v57
    v_lshlrev_b32 v58, 7, v58
    v_and_b32 v59, 3, v2
    v_lshl_add_u32 v58, v59, 3, v58
    v_lshrrev_b32 v57, 1, v57
    v_and_b32 v56, 1, v5
    v_lshl_or_b32 v57, v56, 1, v57
    v_lshlrev_b32 v57, 5, v57
    v_xor_b32 v58, v58, v57
    v_xor_b32 v59, 32, v58
    v_xor_b32 v60, 64, v58
    v_xor_b32 v61, 96, v58
    s_waitcnt vmcnt(4)
    s_barrier
    ds_read_b64_tr_b16 v[64:65], v58 offset:0
    ds_read_b64_tr_b16 v[66:67], v58 offset:512
    ds_read_b64_tr_b16 v[68:69], v58 offset:4096
    ds_read_b64_tr_b16 v[70:71], v58 offset:4608
    ds_read_b64_tr_b16 v[72:73], v59 offset:0
    ds_read_b64_tr_b16 v[74:75], v59 offset:512
    ds_read_b64_tr_b16 v[76:77], v59 offset:4096
    ds_read_b64_tr_b16 v[78:79], v59 offset:4608
    ds_read_b64_tr_b16 v[80:81], v60 offset:0
    ds_read_b64_tr_b16 v[82:83], v60 offset:512
    ds_read_b64_tr_b16 v[84:85], v60 offset:4096
    ds_read_b64_tr_b16 v[86:87], v60 offset:4608
    ds_read_b64_tr_b16 v[88:89], v61 offset:0
    ds_read_b64_tr_b16 v[90:91], v61 offset:512
    ds_read_b64_tr_b16 v[92:93], v61 offset:4096
    ds_read_b64_tr_b16 v[94:95], v61 offset:4608
    s_mov_b32 s48, s44
K1_TILE:
    s_cmp_ge_u32 s48, 32
    s_cbranch_scc1 K1_TILE1
    s_lshl_b32 s3, s48, 11
    s_add_u32 m0, s3, 73728
    s_lshl_b32 s3, s48, 13
    s_add_u32 s3, s3, 262144
    buffer_load_dwordx4 v8, s[12:15], s3 offen lds
    s_add_u32 m0, m0, 1024
    s_nop 0
    buffer_load_dwordx4 v9, s[12:15], s3 offen lds
K1_TILE1:
    v_xor_b32 v11, 64, v10
    s_waitcnt vmcnt(4)
    ds_read_b128 v[16:19], v10
    ds_read_b128 v[20:23], v11
    s_waitcnt lgkmcnt(1)
    v_mfma_f32_16x16x32_bf16 v[96:99], v[64:67], v[16:19], 0
    s_waitcnt lgkmcnt(0)
    v_mfma_f32_16x16x32_bf16 v[96:99], v[68:71], v[20:23], v[96:99]
    v_mfma_f32_16x16x32_bf16 v[100:103], v[72:75], v[16:19], 0
    v_mfma_f32_16x16x32_bf16 v[100:103], v[76:79], v[20:23], v[100:103]
    v_mfma_f32_16x16x32_bf16 v[104:107], v[80:83], v[16:19], 0
    v_mfma_f32_16x16x32_bf16 v[104:107], v[84:87], v[20:23], v[104:107]
    v_mfma_f32_16x16x32_bf16 v[108:111], v[88:91], v[16:19], 0
    v_mfma_f32_16x16x32_bf16 v[108:111], v[92:95], v[20:23], v[108:111]
    s_nop 1
    v_mul_f32 v40, 0xbfb8aa3b, v96
    v_mul_f32 v41, 0xbfb8aa3b, v97
    v_mul_f32 v42, 0xbfb8aa3b, v98
    v_mul_f32 v43, 0xbfb8aa3b, v99
    v_exp_f32 v40, v40
    v_exp_f32 v41, v41
    v_exp_f32 v42, v42
    v_exp_f32 v43, v43
    v_add_f32 v40, 1.0, v40
    v_add_f32 v41, 1.0, v41
    v_add_f32 v42, 1.0, v42
    v_add_f32 v43, 1.0, v43
    v_rcp_f32 v40, v40
    v_rcp_f32 v41, v41
    v_rcp_f32 v42, v42
    v_rcp_f32 v43, v43
    v_mul_f32 v40, v40, v96
    v_mul_f32 v41, v41, v97
    v_mul_f32 v42, v42, v98
    v_mul_f32 v43, v43, v99
    v_cvt_pk_bf16_f32 v16, v40, v41
    v_cvt_pk_bf16_f32 v17, v42, v43
    v_mul_f32 v44, 0xbfb8aa3b, v100
    v_mul_f32 v45, 0xbfb8aa3b, v101
    v_mul_f32 v46, 0xbfb8aa3b, v102
    v_mul_f32 v47, 0xbfb8aa3b, v103
    v_exp_f32 v44, v44
    v_exp_f32 v45, v45
    v_exp_f32 v46, v46
    v_exp_f32 v47, v47
    v_add_f32 v44, 1.0, v44
    v_add_f32 v45, 1.0, v45
    v_add_f32 v46, 1.0, v46
    v_add_f32 v47, 1.0, v47
    v_rcp_f32 v44, v44
    v_rcp_f32 v45, v45
    v_rcp_f32 v46, v46
    v_rcp_f32 v47, v47
    v_mul_f32 v44, v44, v100
    v_mul_f32 v45, v45, v101
    v_mul_f32 v46, v46, v102
    v_mul_f32 v47, v47, v103
    v_cvt_pk_bf16_f32 v18, v44, v45
    v_cvt_pk_bf16_f32 v19, v46, v47
    v_mul_f32 v48, 0xbfb8aa3b, v104
    v_mul_f32 v49, 0xbfb8aa3b, v105
    v_mul_f32 v50, 0xbfb8aa3b, v106
    v_mul_f32 v51, 0xbfb8aa3b, v107
    v_exp_f32 v48, v48
    v_exp_f32 v49, v49
    v_exp_f32 v50, v50
    v_exp_f32 v51, v51
    v_add_f32 v48, 1.0, v48
    v_add_f32 v49, 1.0, v49
    v_add_f32 v50, 1.0, v50
    v_add_f32 v51, 1.0, v51
    v_rcp_f32 v48, v48
    v_rcp_f32 v49, v49
    v_rcp_f32 v50, v50
    v_rcp_f32 v51, v51
    v_mul_f32 v48, v48, v104
    v_mul_f32 v49, v49, v105
    v_mul_f32 v50, v50, v106
    v_mul_f32 v51, v51, v107
    v_cvt_pk_bf16_f32 v20, v48, v49
    v_cvt_pk_bf16_f32 v21, v50, v51
    v_mul_f32 v52, 0xbfb8aa3b, v108
    v_mul_f32 v53, 0xbfb8aa3b, v109
    v_mul_f32 v54, 0xbfb8aa3b, v110
    v_mul_f32 v55, 0xbfb8aa3b, v111
    v_exp_f32 v52, v52
    v_exp_f32 v53, v53
    v_exp_f32 v54, v54
    v_exp_f32 v55, v55
    v_add_f32 v52, 1.0, v52
    v_add_f32 v53, 1.0, v53
    v_add_f32 v54, 1.0, v54
    v_add_f32 v55, 1.0, v55
    v_rcp_f32 v52, v52
    v_rcp_f32 v53, v53
    v_rcp_f32 v54, v54
    v_rcp_f32 v55, v55
    v_mul_f32 v52, v52, v108
    v_mul_f32 v53, v53, v109
    v_mul_f32 v54, v54, v110
    v_mul_f32 v55, v55, v111
    v_cvt_pk_bf16_f32 v22, v52, v53
    v_cvt_pk_bf16_f32 v23, v54, v55
    ds_write_b128 v10, v[16:19]
    ds_write_b128 v11, v[20:23]
    ds_read_b128 v[24:27], v12
    ds_read_b128 v[28:31], v12 offset:1024
    v_add_u32 v10, 0x8000, v10
    v_add_u32 v12, 0x8000, v12
    s_lshl_b32 s3, s48, 11
    s_waitcnt lgkmcnt(1)
    buffer_store_dwordx4 v[24:27], v14, s[16:19], s3 offen sc1
    s_waitcnt lgkmcnt(0)
    buffer_store_dwordx4 v[28:31], v15, s[16:19], s3 offen offset:1024 sc1
    s_add_u32 s48, s48, 16
    s_cmp_lt_u32 s48, 53
    s_cbranch_scc1 K1_TILE
K1_TDONE:
    v_lshlrev_b32 v13, 9, v2
    s_lshl_b32 s3, s44, 15
    s_cmp_lt_u32 s44, 14
    s_cbranch_scc1 K1_NOCPF
    s_getpc_b64 s[24:25]
K1_PC:
    s_add_u32 s24, s24, painn_msg_kernel-K1_PC
    s_addc_u32 s25, s25, 0
    s_mov_b32 s26, K2_END-painn_msg_kernel
    s_mov_b32 s27, 0x20000
    v_and_b32 v4, 127, v0
    v_lshlrev_b32 v4, 6, v4
    buffer_load_dword v5, v4, s[24:27], 0 offen
K1_NOCPF:
    s_endpgm
K1_PREP:
    v_bfe_u32 v1, v0, 2, 2
    v_and_b32 v4, 3, v0
    v_lshlrev_b32 v4, 1, v4
    v_lshl_add_u32 v1, v1, 4, v4
    v_lshrrev_b32 v6, 4, v2
    s_waitcnt lgkmcnt(0)
    s_mov_b32 s24, s76
    s_mov_b32 s25, s77
    s_mov_b32 s26, 24576
    s_mov_b32 s27, 0x20000
    s_mov_b32 s28, s78
    s_mov_b32 s29, s79
    s_mov_b32 s30, 1536
    s_mov_b32 s31, 0x20000
    s_add_u32 s32, s10, 0
    s_addc_u32 s33, s11, 0
    s_mov_b32 s34, 26624
    s_mov_b32 s35, 0x20000
    s_mov_b32 s3, s44
    v_mul_u32_u24 v4, 1536, v6
    v_add_u32 v4, v4, v1
    v_add_u32 v5, 6144, v4
K1_PW2:
    s_and_b32 s36, s3, 1
    s_lshr_b32 s37, s3, 1
    s_mul_i32 s38, s37, 43
    s_lshr_b32 s38, s38, 7
    s_mul_i32 s39, s38, 3
    s_sub_u32 s39, s37, s39
    s_mul_i32 s36, s36, 12288
    s_lshl_b32 s39, s39, 7
    s_add_u32 s36, s36, s39
    s_lshr_b32 s39, s38, 1
    s_lshl_b32 s39, s39, 6
    s_add_u32 s36, s36, s39
    s_and_b32 s39, s38, 1
    s_lshl_b32 s39, s39, 3
    s_add_u32 s36, s36, s39
    buffer_load_ushort v8, v4, s[24:27], s36 offen offset:0
    buffer_load_ushort v9, v4, s[24:27], s36 offen offset:384
    buffer_load_ushort v10, v4, s[24:27], s36 offen offset:768
    buffer_load_ushort v11, v4, s[24:27], s36 offen offset:1152
    buffer_load_ushort v12, v5, s[24:27], s36 offen offset:0
    buffer_load_ushort v13, v5, s[24:27], s36 offen offset:384
    buffer_load_ushort v14, v5, s[24:27], s36 offen offset:768
    buffer_load_ushort v15, v5, s[24:27], s36 offen offset:1152
    s_lshl_b32 s36, s3, 10
    s_waitcnt vmcnt(6)
    v_lshl_or_b32 v16, v9, 16, v8
    s_waitcnt vmcnt(4)
    v_lshl_or_b32 v17, v11, 16, v10
    s_waitcnt vmcnt(2)
    v_lshl_or_b32 v18, v13, 16, v12
    s_waitcnt vmcnt(0)
    v_lshl_or_b32 v19, v15, 16, v14
    buffer_store_dwordx4 v[16:19], v3, s[32:35], s36 offen
    s_add_u32 s3, s3, 16
    s_cmp_lt_u32 s3, 24
    s_cbranch_scc1 K1_PW2
    s_cmp_ge_u32 s3, 28
    s_cbranch_scc1 K1_END
    s_sub_u32 s3, s3, 24
    s_lshr_b32 s36, s3, 1
    s_lshl_b32 s36, s36, 6
    s_and_b32 s37, s3, 1
    s_lshl_b32 s37, s37, 3
    s_add_u32 s36, s36, s37
    v_min_u32 v6, 2, v6
    v_lshl_add_u32 v4, v6, 7, v1
    buffer_load_ushort v8, v4, s[28:31], s36 offen offset:0
    buffer_load_ushort v9, v4, s[28:31], s36 offen offset:384
    buffer_load_ushort v10, v4, s[28:31], s36 offen offset:768
    buffer_load_ushort v11, v4, s[28:31], s36 offen offset:1152
    s_lshr_b32 s36, s3, 1
    s_lshl_b32 s36, s36, 10
    s_add_u32 s36, s36, s37
    s_add_u32 s36, s36, 24576
    s_waitcnt vmcnt(2)
    v_lshl_or_b32 v8, v9, 16, v8
    s_waitcnt vmcnt(0)
    v_lshl_or_b32 v9, v11, 16, v10
    buffer_store_dwordx2 v[8:9], v3, s[32:35], s36 offen
K1_END:
    s_endpgm

.globl painn_msg_kernel
.p2align 8
.type painn_msg_kernel,@function
painn_msg_kernel:
    s_cmp_ge_u32 s2, 256
    s_cbranch_scc1 K2_END
    s_and_b32 s3, s2, 7
    s_lshl_b32 s3, s3, 5
    s_lshr_b32 s2, s2, 3
    s_or_b32 s2, s2, s3
    s_load_dwordx2 s[8:9], s[0:1], 80
    s_load_dwordx2 s[4:5], s[0:1], 0
    s_load_dwordx2 s[6:7], s[0:1], 64
    s_load_dwordx2 s[10:11], s[0:1], 32
    v_lshrrev_b32 v1, 6, v0
    v_and_b32 v2, 63, v0
    v_readfirstlane_b32 s44, v1
    v_lshlrev_b32 v64, 4, v2
    v_mov_b32 v3, 0
    v_lshlrev_b32 v4, 2, v2
    ds_write_b32 v4, v3 offset:47104
    ds_write_b32 v4, v3 offset:47360
    s_mul_i32 s56, s2, 196
    s_lshr_b32 s85, s2, 5
    s_mul_i32 s85, s85, 6272
    s_mov_b32 s47, 0
    s_mov_b32 s57, 1
    s_mov_b32 s61, 1
    s_mov_b32 s55, 0
    s_mov_b32 s84, 0
    s_mov_b32 s54, s44
    s_mov_b32 s52, 0xffff0000
    s_mov_b32 s53, 0x000f000f
    s_waitcnt lgkmcnt(0)
    s_load_dwordx2 s[12:13], s[10:11], 0
    s_add_u32 s32, s8, 65536
    s_addc_u32 s33, s9, 0
    s_mov_b32 s34, 200704
    s_mov_b32 s35, 0x20000
    s_lshl_b32 s3, s44, 16
    s_lshl_b32 s60, s2, 2
    s_add_u32 s3, s3, s60
    v_lshlrev_b32 v120, 6, v64
    buffer_load_dword v124, v120, s[32:35], s3 offen
    s_barrier
    s_add_u32 s40, s8, 0
    s_addc_u32 s41, s9, 0
    s_mov_b32 s42, 26624
    s_mov_b32 s43, 0x20000
    s_add_u32 s3, s44, 0
    s_lshl_b32 s3, s3, 10
    s_mov_b32 m0, s3
    s_nop 0
    buffer_load_dwordx4 v64, s[40:43], s3 offen lds
    s_add_u32 s3, s44, 12
    s_lshl_b32 s3, s3, 10
    s_mov_b32 m0, s3
    s_nop 0
    buffer_load_dwordx4 v64, s[40:43], s3 offen lds
    s_cmp_lt_u32 s44, 2
    s_cselect_b64 exec, -1, 1
    s_cselect_b32 s60, 12288, 0
    s_add_u32 s3, s3, s60
    s_mov_b32 m0, s3
    s_nop 0
    buffer_load_dwordx4 v64, s[40:43], s3 offen lds
    s_mov_b64 exec, -1
    s_add_u32 s60, s56, 196
    s_min_u32 s60, s60, 50000
    s_sub_u32 s60, s60, s56
    s_lshl_b32 s60, s60, 9
    s_lshl_b32 s3, s56, 9
    s_add_u32 s24, s4, s3
    s_addc_u32 s25, s5, 0
    s_mov_b32 s26, s60
    s_mov_b32 s27, 0x20000
    s_add_u32 s28, s6, s3
    s_addc_u32 s29, s7, 0
    s_mov_b32 s30, s60
    s_mov_b32 s31, 0x20000
    v_lshlrev_b32 v5, 2, v2
    v_and_b32 v5, 0x40, v5
    v_and_b32 v6, 0x20, v2
    v_or_b32 v5, v5, v6
    v_and_b32 v6, 0x70, v64
    v_xor_b32 v115, v5, v6
    v_mov_b32 v117, v115
    v_lshrrev_b32 v6, 4, v2
    v_lshrrev_b32 v5, 3, v2
    v_lshlrev_b32 v118, 2, v5
    v_lshl_add_u32 v160, v118, 7, v115
    v_lshl_add_u32 v161, v118, 7, v117
    v_add_u32 v161, 4096, v161
    s_add_u32 s60, s44, 0
    s_sub_u32 s3, s60, 4
    s_cselect_b32 s3, 48, s3
    s_lshr_b32 s3, s3, 2
    s_lshl_b32 s3, s3, 13
    s_and_b32 s18, s60, 3
    s_lshl_b32 s19, s18, 11
    s_add_u32 s19, s19, s3
    s_add_u32 m0, s19, 47616
    s_lshl_b32 s18, s18, 7
    s_add_u32 s3, s3, s18
    buffer_load_dwordx4 v160, s[24:27], s3 offen lds
    s_add_u32 m0, m0, 1024
    s_nop 0
    buffer_load_dwordx4 v161, s[24:27], s3 offen lds
    s_add_u32 s36, s8, 393216
    s_addc_u32 s37, s9, 0
    s_mov_b32 s38, 9633792
    s_mov_b32 s39, 0x20000
    s_add_u32 s80, s8, 33554432
    s_addc_u32 s81, s9, 0
    s_mov_b32 s82, 50000
    s_mov_b32 s83, 0x20000
    s_or_b32 s81, s81, 0x800000
    s_mov_b32 s20, s4
    s_mov_b32 s21, s5
    s_mov_b32 s22, 50000
    s_mov_b32 s23, 0x20000
    s_or_b32 s21, s21, 0x2000000
    v_and_b32 v5, 15, v2
    v_lshlrev_b32 v119, 3, v5
    v_sub_u32 v67, 15, v5
    v_mul_u32_u24 v67, 0x10001, v67
    v_lshlrev_b32 v6, 2, v6
    v_sub_u32 v5, v5, v6
    v_mov_b32 v7, 0x3f80
    v_mov_b32 v8, 0x3f800000
    v_cmp_eq_u32 vcc, 0, v5
    s_nop 1
    v_cndmask_b32 v112, 0, v7, vcc
    v_cmp_eq_u32 vcc, 1, v5
    s_nop 1
    v_cndmask_b32 v112, v112, v8, vcc
    v_cmp_eq_u32 vcc, 2, v5
    s_nop 1
    v_cndmask_b32 v113, 0, v7, vcc
    v_cmp_eq_u32 vcc, 3, v5
    s_nop 1
    v_cndmask_b32 v113, v113, v8, vcc
    s_min_u32 s45, s54, 12
    s_lshl_b32 s45, s45, 13
    s_add_u32 s45, s45, 47616
    v_lshlrev_b32 v120, 1, v64
    v_and_b32 v120, 0x40, v120
    v_lshrrev_b32 v121, 1, v64
    v_and_b32 v121, 0x20, v121
    v_or_b32 v120, v120, v121
    v_lshrrev_b32 v121, 4, v64
    v_and_b32 v121, 0x30, v121
    v_xor_b32 v120, v120, v121
    v_lshl_add_u32 v120, v119, 4, v120
    v_add_u32 v65, s45, v120
    v_xor_b32 v66, 64, v65
    s_waitcnt lgkmcnt(0)
    s_lshl_b32 s14, s12, 16
    s_and_b32 s15, s12, s52
    s_lshl_b32 s16, s13, 16
    s_and_b32 s17, s13, s52
    s_cmp_ge_u32 s44, 4
    s_cbranch_scc1 K2_B1
    s_waitcnt vmcnt(5)
K2_A2:
    v_lshrrev_b32 v125, 16, v124
    v_and_b32 v126, 0xffff, v124
    v_mov_b32 v127, v125
    s_nop 1
    v_add_u32_dpp v127, v127, v127 row_shr:1 row_mask:0xf bank_mask:0xf
    s_nop 1
    v_add_u32_dpp v127, v127, v127 row_shr:2 row_mask:0xf bank_mask:0xf
    s_nop 1
    v_add_u32_dpp v127, v127, v127 row_shr:4 row_mask:0xf bank_mask:0xf
    s_nop 1
    v_add_u32_dpp v127, v127, v127 row_shr:8 row_mask:0xf bank_mask:0xf
    s_nop 1
    v_add_u32_dpp v127, v127, v127 row_bcast:15 row_mask:0xa bank_mask:0xf
    s_nop 1
    v_add_u32_dpp v127, v127, v127 row_bcast:31 row_mask:0xc bank_mask:0xf
    s_cmp_eq_u32 s57, 0
    s_cbranch_scc1 K2_B0
    v_readlane_b32 s3, v127, 63
    v_mov_b32 v120, 47360
    s_nop 0
    v_mov_b32 v121, s3
    s_mov_b64 exec, 1
    ds_add_rtn_u32 v121, v120, v121
    s_mov_b64 exec, -1
    s_waitcnt lgkmcnt(0)
    v_readfirstlane_b32 s48, v121
K2_B0:
    v_sub_u32 v127, v127, v125
    s_sub_u32 s3, s48, s47
    v_add_u32 v127, s3, v127
    v_sub_u32 v128, 0, v127
    v_max_i32 v128, 0, v128
    v_sub_u32 v129, 768, v127
    v_min_i32 v129, v129, v125
    v_lshrrev_b32 v120, 4, v64
    s_lshl_b32 s3, s44, 6
    v_add_u32 v120, s3, v120
    v_mul_u32_u24 v120, 4096, v120
    v_add3_u32 v120, v120, v126, v128
    v_mul_u32_u24 v120, 12, v120
    v_add_u32 v127, v127, v128
    v_lshlrev_b32 v127, 2, v127
    v_sub_u32 v129, v129, v128
K2_BL:
    v_cmp_lt_i32 vcc, 0, v129
    s_and_b64 exec, exec, vcc
    s_cbranch_execz K2_BX
    ds_write_b32 v127, v120 offset:26624
    v_add_u32 v129, -1, v129
    v_add_u32 v127, 4, v127
    v_add_u32 v120, 12, v120
    s_branch K2_BL
K2_BX:
    s_mov_b64 exec, -1
K2_B1:
    s_waitcnt lgkmcnt(0)
    s_barrier
    v_mov_b32 v120, 47360
    ds_read_b32 v120, v120
    v_lshrrev_b32 v121, 2, v64
    s_lshl_b32 s3, s44, 8
    v_add_u32 v121, s3, v121
    ds_read_b32 v122, v121 offset:26624
    s_waitcnt lgkmcnt(1)
    v_readfirstlane_b32 s46, v120
    s_sub_u32 s3, s46, s47
    s_min_u32 s3, s3, 768
    s_lshl_b32 s3, s3, 2
    v_cmp_gt_u32 vcc, s3, v121
    s_mov_b64 s[58:59], vcc
    s_mov_b64 exec, vcc
    s_waitcnt lgkmcnt(0)
    buffer_load_dwordx3 v[124:126], v122, s[36:39], 0 offen
    s_mov_b64 exec, -1
    s_cmp_eq_u32 s57, 0
    s_cbranch_scc1 K2_HAX
    s_cmp_lt_u32 s44, 10
    s_cbranch_scc1 K2_HAX
    s_add_u32 s60, s44, 2
K2_HAL:
    s_cmp_ge_u32 s60, 28
    s_cbranch_scc1 K2_HAX
    s_sub_u32 s3, s60, 4
    s_cselect_b32 s3, 48, s3
    s_lshr_b32 s3, s3, 2
    s_lshl_b32 s3, s3, 13
    s_and_b32 s18, s60, 3
    s_lshl_b32 s19, s18, 11
    s_add_u32 s19, s19, s3
    s_add_u32 m0, s19, 47616
    s_lshl_b32 s18, s18, 7
    s_add_u32 s3, s3, s18
    buffer_load_dwordx4 v160, s[24:27], s3 offen lds
    s_add_u32 m0, m0, 1024
    s_nop 0
    buffer_load_dwordx4 v161, s[24:27], s3 offen lds
    s_add_u32 s60, s60, 2
    s_branch K2_HAL
K2_HAX:
    s_cmp_eq_u64 s[58:59], 0
    s_cbranch_scc1 K2_C2
    s_waitcnt vmcnt(0)
    v_lshlrev_b32 v145, 16, v125
    v_and_b32 v146, 0xffff0000, v125
    v_and_b32 v147, 0xffff0000, v126
    v_mul_f32 v141, v145, v145
    v_mul_f32 v142, v146, v146
    v_mul_f32 v138, v147, v147
    v_cvt_pk_bf16_f32 v142, v141, v142
    v_lshlrev_b32 v141, 16, v142
    v_and_b32 v142, 0xffff0000, v142
    v_cvt_pk_bf16_f32 v138, v138, v138
    v_and_b32 v138, 0xffff0000, v138
    v_lshrrev_b32 v135, 16, v124
    v_add_f32 v141, v141, v142
    v_subrev_u32 v135, s56, v135
    v_add_f32 v138, v141, v138
    v_and_b32 v134, 15, v135
    v_cvt_pk_bf16_f32 v138, v138, v138
    v_and_b32 v138, 0xffff0000, v138
    v_and_b32 v128, 0xffff, v124
    v_and_b32 v135, -16, v135
    v_subrev_u32 v142, s85, v128
    v_add_u32 v143, 50000, v142
    v_min_u32 v142, v142, v143
    v_add_u32 v142, 8304, v142
    v_mul_u32_u24 v142, 72, v142
    v_lshrrev_b32 v142, 18, v142
    v_xor_b32 v142, 12, v142
    v_and_or_b32 v135, v142, 12, v135
    v_subrev_u32 v141, 0x41c00000, v138
    v_cmp_le_u32 vcc, 0x3dc00000, v141
    v_mov_b32 v136, 1
    s_and_b64 s[58:59], s[58:59], vcc
    s_mov_b64 exec, s[58:59]
    ds_add_rtn_u32 v136, v135, v136 offset:47104
    s_mov_b64 exec, -1
    v_lshlrev_b32_e64 v134, v134, 1
    v_add_f32 v138, 0x322bcc77, v138
    v_cvt_pk_bf16_f32 v138, v138, v138
    v_and_b32 v138, 0xffff0000, v138
    v_sqrt_f32 v138, v138
    s_nop 0
    v_cvt_pk_bf16_f32 v138, v138, v138
    v_and_b32 v138, 0xffff0000, v138
    v_rcp_f32 v139, v138
    v_mul_f32 v140, 0x40490fdb, v138
    v_mul_f32 v141, s14, v138
    v_mul_f32 v142, s15, v138
    v_mul_f32 v143, s16, v138
    v_mul_f32 v144, s17, v138
    v_cvt_pk_bf16_f32 v140, v140, v140
    v_and_b32 v140, 0xffff0000, v140
    v_cvt_pk_bf16_f32 v142, v141, v142
    v_lshlrev_b32 v141, 16, v142
    v_and_b32 v142, 0xffff0000, v142
    v_cvt_pk_bf16_f32 v144, v143, v144
    v_lshlrev_b32 v143, 16, v144
    v_and_b32 v144, 0xffff0000, v144
    v_mul_f32 v140, 0x3e4ccccd, v140
    v_cvt_pk_bf16_f32 v140, v140, v140
    v_and_b32 v140, 0xffff0000, v140
    v_mul_f32 v140, 0.15915494, v140
    v_mul_f32 v141, 0.15915494, v141
    v_mul_f32 v142, 0.15915494, v142
    v_mul_f32 v143, 0.15915494, v143
    v_mul_f32 v144, 0.15915494, v144
    v_fract_f32 v141, v141
    v_fract_f32 v142, v142
    v_fract_f32 v143, v143
    v_fract_f32 v144, v144
    v_cos_f32 v140, v140
    v_sin_f32 v141, v141
    v_sin_f32 v142, v142
    v_sin_f32 v143, v143
    v_sin_f32 v144, v144
    v_cvt_pk_bf16_f32 v140, v140, v140
    v_and_b32 v140, 0xffff0000, v140
    v_cvt_pk_bf16_f32 v142, v141, v142
    v_lshlrev_b32 v141, 16, v142
    v_and_b32 v142, 0xffff0000, v142
    v_cvt_pk_bf16_f32 v144, v143, v144
    v_lshlrev_b32 v143, 16, v144
    v_and_b32 v144, 0xffff0000, v144
    v_add_f32 v140, 1.0, v140
    v_mul_f32 v141, v141, v139
    v_mul_f32 v142, v142, v139
    v_mul_f32 v143, v143, v139
    v_mul_f32 v144, v144, v139
    v_cvt_pk_bf16_f32 v140, v140, v140
    v_and_b32 v140, 0xffff0000, v140
    v_cvt_pk_bf16_f32 v142, v141, v142
    v_lshlrev_b32 v141, 16, v142
    v_and_b32 v142, 0xffff0000, v142
    v_cvt_pk_bf16_f32 v144, v143, v144
    v_lshlrev_b32 v143, 16, v144
    v_and_b32 v144, 0xffff0000, v144
    v_mul_f32 v140, 0.5, v140
    v_mul_f32 v145, v145, v139
    v_mul_f32 v146, v146, v139
    v_mul_f32 v147, v147, v139
    v_mul_f32 v141, v141, v140
    v_mul_f32 v142, v142, v140
    v_mul_f32 v143, v143, v140
    v_mul_f32 v144, v144, v140
    v_cvt_pk_bf16_f32 v132, v145, v146
    v_cvt_pk_bf16_f32 v133, v147, v147
    v_cvt_pk_bf16_f32 v130, v141, v142
    v_cvt_pk_bf16_f32 v131, v143, v144
K2_C2:
    s_waitcnt lgkmcnt(0)
    s_barrier
    s_cmp_eq_u32 s57, 0
    s_cbranch_scc1 K2_HBX
    s_cmp_lt_u32 s44, 10
    s_cbranch_scc1 K2_HBX
    s_add_u32 s60, s44, 18
K2_HBL:
    s_cmp_ge_u32 s60, 44
    s_cbranch_scc1 K2_HBX
    s_sub_u32 s3, s60, 4
    s_cselect_b32 s3, 48, s3
    s_lshr_b32 s3, s3, 2
    s_lshl_b32 s3, s3, 13
    s_and_b32 s18, s60, 3
    s_lshl_b32 s19, s18, 11
    s_add_u32 s19, s19, s3
    s_add_u32 m0, s19, 47616
    s_lshl_b32 s18, s18, 7
    s_add_u32 s3, s3, s18
    buffer_load_dwordx4 v160, s[24:27], s3 offen lds
    s_add_u32 m0, m0, 1024
    s_nop 0
    buffer_load_dwordx4 v161, s[24:27], s3 offen lds
    s_add_u32 s60, s60, 2
    s_branch K2_HBL
K2_HBX:
    v_lshrrev_b32 v121, 2, v64
    ds_read_b32 v123, v121 offset:47104
    v_lshrrev_b32 v120, 3, v119
    s_lshl_b32 s3, s54, 2
    s_lshl_b32 s60, s44, 2
    s_mov_b32 vcc_lo, 0x88888888
    s_mov_b32 vcc_hi, 0x88888888
    s_waitcnt lgkmcnt(0)
    v_add_u32_dpp v121, v123, v123 quad_perm:[1,0,3,2] row_mask:0xf bank_mask:0xf
    s_nop 1
    v_add_u32_dpp v121, v121, v121 quad_perm:[2,3,0,1] row_mask:0xf bank_mask:0xf
    v_sub_u32 v122, 0, v121
    v_and_b32 v122, 15, v122
    v_cndmask_b32 v122, 0, v122, vcc
    v_add_u32 v122, v122, v123
    v_mov_b32 v123, v122
    s_nop 1
    v_add_u32_dpp v123, v123, v123 row_shr:1 row_mask:0xf bank_mask:0xf
    s_nop 1
    v_add_u32_dpp v123, v123, v123 row_shr:2 row_mask:0xf bank_mask:0xf
    s_nop 1
    v_add_u32_dpp v123, v123, v123 row_shr:4 row_mask:0xf bank_mask:0xf
    s_nop 1
    v_add_u32_dpp v123, v123, v123 row_shr:8 row_mask:0xf bank_mask:0xf
    s_nop 1
    v_add_u32_dpp v123, v123, v123 row_bcast:15 row_mask:0xa bank_mask:0xf
    s_nop 1
    v_add_u32_dpp v123, v123, v123 row_bcast:31 row_mask:0xc bank_mask:0xf
    v_sub_u32 v123, v123, v122
    ds_bpermute_b32 v122, v135, v123
    v_readlane_b32 s49, v121, s3
    v_readlane_b32 s50, v123, s3
    v_readlane_b32 s62, v121, 48
    v_readlane_b32 s63, v123, 48
    v_readlane_b32 s18, v121, s60
    v_readlane_b32 s19, v123, s60
    s_waitcnt lgkmcnt(0)
    v_add_u32 v136, v136, v122
    v_lshrrev_b32 v122, 4, v136
    v_mul_u32_u24 v122, 320, v122
    v_and_b32 v123, 15, v136
    v_lshl_add_u32 v141, v123, 2, v122
    v_lshl_add_u32 v142, v123, 3, v122
    v_lshrrev_b32 v123, 2, v123
    v_lshl_add_u32 v143, v123, 5, v122
    v_and_b32 v123, 3, v136
    v_lshl_add_u32 v143, v123, 1, v143
    s_mov_b64 exec, s[58:59]
    ds_write_b32 v141, v128 offset:26624
    ds_write_b64 v142, v[130:131] offset:26688
    ds_write_b16 v143, v132 offset:26816
    ds_write_b16_d16_hi v143, v132 offset:26824
    ds_write_b16 v143, v133 offset:26832
    ds_write_b16 v143, v134 offset:26840
    s_mov_b64 exec, -1
    v_lshrrev_b32 v123, 2, v120
    v_lshlrev_b32 v143, 5, v123
    v_and_b32 v123, 3, v120
    v_lshl_add_u32 v143, v123, 1, v143
    v_mov_b32 v128, 0xffffff
    v_mov_b32 v130, 0
    v_mov_b32 v131, 0
    s_mov_b32 s60, s44
K2_D0:
    s_and_b32 s3, s18, 15
    s_cbranch_scc0 K2_D1
    s_add_u32 s18, s18, s19
    s_lshr_b32 s18, s18, 4
    s_mul_i32 s18, s18, 320
    v_lshl_add_u32 v141, v120, 2, s18
    v_add_u32 v142, s18, v119
    v_add_u32 v144, s18, v143
    v_cmp_le_u32 vcc, s3, v120
    s_mov_b64 exec, vcc
    ds_write_b32 v141, v128 offset:26624
    ds_write_b64 v142, v[130:131] offset:26688
    ds_write_b16 v144, v130 offset:26840
    s_mov_b64 exec, -1
K2_D1:
    s_mov_b32 s18, s62
    s_mov_b32 s19, s63
    s_add_u32 s60, s60, 1
    s_cmp_eq_u32 s60, 12
    s_cbranch_scc1 K2_D0
    s_cmp_eq_u32 s57, 0
    s_cbranch_scc1 K2_HCX
    s_cmp_lt_u32 s44, 10
    s_cbranch_scc1 K2_HCX
    s_lshl_b32 s60, s44, 2
    s_add_u32 s60, s60, 4
    s_sub_u32 s3, s60, 4
    s_cselect_b32 s3, 48, s3
    s_lshr_b32 s3, s3, 2
    s_lshl_b32 s3, s3, 13
    s_and_b32 s18, s60, 3
    s_lshl_b32 s19, s18, 11
    s_add_u32 s19, s19, s3
    s_add_u32 m0, s19, 47616
    s_lshl_b32 s18, s18, 7
    s_add_u32 s3, s3, s18
    buffer_load_dwordx4 v160, s[24:27], s3 offen lds
    s_add_u32 m0, m0, 1024
    s_nop 0
    buffer_load_dwordx4 v161, s[24:27], s3 offen lds
    s_add_u32 s60, s60, 1
    s_sub_u32 s3, s60, 4
    s_cselect_b32 s3, 48, s3
    s_lshr_b32 s3, s3, 2
    s_lshl_b32 s3, s3, 13
    s_and_b32 s18, s60, 3
    s_lshl_b32 s19, s18, 11
    s_add_u32 s19, s19, s3
    s_add_u32 m0, s19, 47616
    s_lshl_b32 s18, s18, 7
    s_add_u32 s3, s3, s18
    buffer_load_dwordx4 v160, s[24:27], s3 offen lds
    s_add_u32 m0, m0, 1024
    s_nop 0
    buffer_load_dwordx4 v161, s[24:27], s3 offen lds
    s_add_u32 s60, s60, 1
    s_sub_u32 s3, s60, 4
    s_cselect_b32 s3, 48, s3
    s_lshr_b32 s3, s3, 2
    s_lshl_b32 s3, s3, 13
    s_and_b32 s18, s60, 3
    s_lshl_b32 s19, s18, 11
    s_add_u32 s19, s19, s3
    s_add_u32 m0, s19, 47616
    s_lshl_b32 s18, s18, 7
    s_add_u32 s3, s3, s18
    buffer_load_dwordx4 v160, s[24:27], s3 offen lds
    s_add_u32 m0, m0, 1024
    s_nop 0
    buffer_load_dwordx4 v161, s[24:27], s3 offen lds
    s_add_u32 s60, s60, 1
    s_sub_u32 s3, s60, 4
    s_cselect_b32 s3, 48, s3
    s_lshr_b32 s3, s3, 2
    s_lshl_b32 s3, s3, 13
    s_and_b32 s18, s60, 3
    s_lshl_b32 s19, s18, 11
    s_add_u32 s19, s19, s3
    s_add_u32 m0, s19, 47616
    s_lshl_b32 s18, s18, 7
    s_add_u32 s3, s3, s18
    buffer_load_dwordx4 v160, s[24:27], s3 offen lds
    s_add_u32 m0, m0, 1024
    s_nop 0
    buffer_load_dwordx4 v161, s[24:27], s3 offen lds
K2_HCX:
    s_cmp_ge_u32 s44, 10
    s_cselect_b32 s3, s57, 0
    s_cmp_lg_u32 s3, 0
    s_cbranch_scc1 K2_D2
    s_waitcnt vmcnt(0)
K2_D2:
    s_mov_b32 s57, 0
    s_waitcnt vmcnt(8) lgkmcnt(0)
    s_barrier
    s_waitcnt vmcnt(0)
K2_G:
    s_add_u32 s51, s49, 15
    s_lshr_b32 s51, s51, 4
    s_lshr_b32 s50, s50, 4
    s_mul_i32 s50, s50, 320
    s_add_u32 s50, s50, 26624
    s_mul_i32 s3, s51, 320
    s_add_u32 s50, s50, s3
    s_sub_u32 s50, s50, 640
    v_add_u32 v120, s50, v118
    ds_read_b32 v114, v120 offset:320
    ds_read_b32 v116, v120 offset:352
    s_cmp_eq_u32 s61, 0
    s_cbranch_scc1 K2_MAIN
    ds_read_b128 v[120:123], v65 offset:0
    ds_read_b128 v[124:127], v66 offset:0
    ds_read_b128 v[128:131], v65 offset:2048
    ds_read_b128 v[132:135], v66 offset:2048
    ds_read_b128 v[136:139], v65 offset:4096
    ds_read_b128 v[140:143], v66 offset:4096
    ds_read_b128 v[144:147], v65 offset:6144
    ds_read_b128 v[148:151], v66 offset:6144
    s_mov_b32 s61, 0
    s_waitcnt lgkmcnt(0)
    s_cmp_eq_u32 s51, 0
    s_cbranch_scc1 K2_G1
    s_mov_b32 m0, s45
    s_nop 0
    buffer_load_dwordx4 v[114:115], s[80:83], 0 idxen offen offset:0 lds
    s_addk_i32 m0, 1024
    s_nop 0
    buffer_load_dwordx4 v[116:117], s[80:83], 0 idxen offen offset:0 lds
    s_addk_i32 m0, 896
    s_nop 0
    buffer_load_dwordx4 v[114:115], s[20:23], 0 idxen offen offset:128 lds
    s_addk_i32 m0, 1024
    s_nop 0
    buffer_load_dwordx4 v[116:117], s[20:23], 0 idxen offen offset:128 lds
    s_addk_i32 m0, 896
    s_nop 0
    buffer_load_dwordx4 v[114:115], s[20:23], 0 idxen offen offset:256 lds
    s_addk_i32 m0, 1024
    s_nop 0
    buffer_load_dwordx4 v[116:117], s[20:23], 0 idxen offen offset:256 lds
    s_addk_i32 m0, 896
    s_nop 0
    buffer_load_dwordx4 v[114:115], s[20:23], 0 idxen offen offset:384 lds
    s_addk_i32 m0, 1024
    s_nop 0
    buffer_load_dwordx4 v[116:117], s[20:23], 0 idxen offen offset:384 lds
K2_G1:
    v_lshlrev_b32 v0, 16, v120
    v_and_b32 v1, 0xffff0000, v120
    v_lshlrev_b32 v2, 16, v121
    v_and_b32 v3, 0xffff0000, v121
    v_lshlrev_b32 v4, 16, v122
    v_and_b32 v5, 0xffff0000, v122
    v_lshlrev_b32 v6, 16, v123
    v_and_b32 v7, 0xffff0000, v123
    v_lshlrev_b32 v8, 16, v124
    v_and_b32 v9, 0xffff0000, v124
    v_lshlrev_b32 v10, 16, v125
    v_and_b32 v11, 0xffff0000, v125
    v_lshlrev_b32 v12, 16, v126
    v_and_b32 v13, 0xffff0000, v126
    v_lshlrev_b32 v14, 16, v127
    v_and_b32 v15, 0xffff0000, v127
    v_lshlrev_b32 v16, 16, v128
    v_and_b32 v17, 0xffff0000, v128
    v_lshlrev_b32 v18, 16, v129
    v_and_b32 v19, 0xffff0000, v129
    v_lshlrev_b32 v20, 16, v130
    v_and_b32 v21, 0xffff0000, v130
    v_lshlrev_b32 v22, 16, v131
    v_and_b32 v23, 0xffff0000, v131
    v_lshlrev_b32 v24, 16, v132
    v_and_b32 v25, 0xffff0000, v132
    v_lshlrev_b32 v26, 16, v133
    v_and_b32 v27, 0xffff0000, v133
    v_lshlrev_b32 v28, 16, v134
    v_and_b32 v29, 0xffff0000, v134
    v_lshlrev_b32 v30, 16, v135
    v_and_b32 v31, 0xffff0000, v135
    v_lshlrev_b32 v32, 16, v136
    v_and_b32 v33, 0xffff0000, v136
    v_lshlrev_b32 v34, 16, v137
    v_and_b32 v35, 0xffff0000, v137
    v_lshlrev_b32 v36, 16, v138
    v_and_b32 v37, 0xffff0000, v138
    v_lshlrev_b32 v38, 16, v139
    v_and_b32 v39, 0xffff0000, v139
    v_lshlrev_b32 v40, 16, v140
    v_and_b32 v41, 0xffff0000, v140
    v_lshlrev_b32 v42, 16, v141
    v_and_b32 v43, 0xffff0000, v141
    v_lshlrev_b32 v44, 16, v142
    v_and_b32 v45, 0xffff0000, v142
    v_lshlrev_b32 v46, 16, v143
    v_and_b32 v47, 0xffff0000, v143
    v_lshlrev_b32 v48, 16, v144
    v_and_b32 v49, 0xffff0000, v144
    v_lshlrev_b32 v50, 16, v145
    v_and_b32 v51, 0xffff0000, v145
    v_lshlrev_b32 v52, 16, v146
    v_and_b32 v53, 0xffff0000, v146
    v_lshlrev_b32 v54, 16, v147
    v_and_b32 v55, 0xffff0000, v147
    v_lshlrev_b32 v56, 16, v148
    v_and_b32 v57, 0xffff0000, v148
    v_lshlrev_b32 v58, 16, v149
    v_and_b32 v59, 0xffff0000, v149
    v_lshlrev_b32 v60, 16, v150
    v_and_b32 v61, 0xffff0000, v150
    v_lshlrev_b32 v62, 16, v151
    v_and_b32 v63, 0xffff0000, v151
    s_cmp_eq_u32 s51, 0
    s_cbranch_scc1 K2_NEXT
    s_branch K2_HT0
K2_MAIN:
    s_cmp_eq_u32 s51, 0
    s_cbranch_scc1 K2_NEXT
    s_mov_b32 m0, s45
    s_waitcnt lgkmcnt(0)
    buffer_load_dwordx4 v[114:115], s[80:83], 0 idxen offen offset:0 lds
    s_addk_i32 m0, 1024
    s_nop 0
    buffer_load_dwordx4 v[116:117], s[80:83], 0 idxen offen offset:0 lds
    s_addk_i32 m0, 896
    s_nop 0
    buffer_load_dwordx4 v[114:115], s[20:23], 0 idxen offen offset:128 lds
    s_addk_i32 m0, 1024
    s_nop 0
    buffer_load_dwordx4 v[116:117], s[20:23], 0 idxen offen offset:128 lds
    s_addk_i32 m0, 896
    s_nop 0
    buffer_load_dwordx4 v[114:115], s[20:23], 0 idxen offen offset:256 lds
    s_addk_i32 m0, 1024
    s_nop 0
    buffer_load_dwordx4 v[116:117], s[20:23], 0 idxen offen offset:256 lds
    s_addk_i32 m0, 896
    s_nop 0
    buffer_load_dwordx4 v[114:115], s[20:23], 0 idxen offen offset:384 lds
    s_addk_i32 m0, 1024
    s_nop 0
    buffer_load_dwordx4 v[116:117], s[20:23], 0 idxen offen offset:384 lds
K2_HT0:
K2_HT:
    s_add_u32 s3, s51, s84
    s_cmp_ge_u32 s3, 4
    s_cbranch_scc1 K2_Q3
    s_cmp_eq_u32 s3, 3
    s_cbranch_scc1 K2_Q2
    s_cmp_eq_u32 s3, 2
    s_cbranch_scc1 K2_Q1
    s_setprio 0
    s_branch K2_Q0
K2_Q3:
    s_setprio 3
    s_branch K2_Q0
K2_Q2:
    s_setprio 2
    s_branch K2_Q0
K2_Q1:
    s_setprio 1
K2_Q0:
    v_lshrrev_b32 v132, 3, v64
    v_add_u32 v133, s50, v119
    v_and_b32 v132, 0x60, v132
    v_add_u32 v134, s50, v118
    v_add_u32 v132, s50, v132
    ds_read_b64 v[110:111], v133 offset:384
    ds_read_b128 v[136:139], v132 offset:512
    ds_read_b128 v[140:143], v132 offset:528
    ds_read_b32 v114, v134 offset:0
    ds_read_b32 v116, v134 offset:32
    ds_read_b64 v[154:155], v64 offset:24576
    ds_read_b128 v[120:123], v64 offset:4096
    ds_read_b128 v[124:127], v64 offset:5120
    ds_read_b128 v[128:131], v64 offset:0
    ds_read_b128 v[156:159], v64 offset:1024
    ds_read_b128 v[160:163], v64 offset:2048
    ds_read_b128 v[164:167], v64 offset:3072
    s_sub_u32 s50, s50, 320
    s_sub_u32 s51, s51, 1
    s_waitcnt lgkmcnt(9)
    v_pk_lshlrev_b16 v142, v67, v142
    v_pk_lshlrev_b16 v143, v67, v143
    v_pk_ashrrev_i16 v142, s53, v142
    v_pk_ashrrev_i16 v143, s53, v143
    v_and_b32 v102, 0x3f803f80, v142
    v_and_b32 v103, 0x3f803f80, v143
    v_and_b32 v106, 0x3f803f80, v142
    v_and_b32 v107, 0x3f803f80, v143
    v_and_b32 v104, v142, v136
    v_and_b32 v105, v143, v137
    v_and_b32 v100, v142, v138
    v_and_b32 v101, v143, v139
    v_and_b32 v108, v142, v140
    v_and_b32 v109, v143, v141
    s_waitcnt vmcnt(6)
    ds_read_b128 v[68:71], v65 offset:0
    ds_read_b128 v[72:75], v66 offset:0
    s_waitcnt lgkmcnt(1)
    v_mfma_f32_16x16x32_bf16 v[144:147], v[68:71], v[120:123], 0
    s_waitcnt lgkmcnt(0)
    v_mfma_f32_16x16x32_bf16 v[144:147], v[72:75], v[124:127], v[144:147]
    v_mfma_f32_16x16x32_bf16 v[140:143], v[68:71], v[128:131], 0
    v_mfma_f32_16x16x4_4b_bf16 v[120:135], v[110:111], v[154:155], 0
    ds_read_b64 v[154:155], v64 offset:24584
    s_waitcnt vmcnt(0)
    ds_read_b128 v[76:79], v65 offset:2048
    ds_read_b128 v[80:83], v66 offset:2048
    ds_read_b128 v[84:87], v65 offset:4096
    ds_read_b128 v[88:91], v66 offset:4096
    ds_read_b128 v[92:95], v65 offset:6144
    ds_read_b128 v[96:99], v66 offset:6144
    v_mfma_f32_16x16x32_bf16 v[140:143], v[72:75], v[156:159], v[140:143]
    ds_read_b128 v[156:159], v64 offset:10240
    v_mfma_f32_16x16x32_bf16 v[136:139], v[68:71], v[160:163], 0
    ds_read_b128 v[160:163], v64 offset:11264
    v_mfma_f32_16x16x32_bf16 v[136:139], v[72:75], v[164:167], v[136:139]
    ds_read_b128 v[164:167], v64 offset:6144
    s_cmp_lg_u32 s51, 0
    s_cselect_b64 vcc, -1, 0
    s_waitcnt lgkmcnt(0)
    s_cbranch_vccz K2_NOPF0
    s_mov_b32 m0, s45
    s_nop 0
    buffer_load_dwordx4 v[114:115], s[80:83], 0 idxen offen offset:0 lds
    s_addk_i32 m0, 1024
    s_nop 0
    buffer_load_dwordx4 v[116:117], s[80:83], 0 idxen offen offset:0 lds
    s_addk_i32 m0, 896
K2_NOPF0:
    v_mfma_f32_16x16x16_bf16 v[132:135], v[84:85], v[112:113], 0
    v_mul_f32 v144, v144, v128
    v_mul_f32 v145, v145, v129
    v_mul_f32 v146, v146, v130
    v_mul_f32 v147, v147, v131
    v_mfma_f32_16x16x16_bf16 v[128:131], v[92:93], v[112:113], 0
    v_cvt_pk_bf16_f32 v150, v144, v145
    v_cvt_pk_bf16_f32 v151, v146, v147
    v_mfma_f32_16x16x32_bf16 v[144:147], v[68:71], v[156:159], 0
    ds_read_b128 v[156:159], v64 offset:7168
    v_mul_f32 v140, v140, v120
    v_mul_f32 v141, v141, v121
    v_mul_f32 v142, v142, v122
    v_mul_f32 v143, v143, v123
    v_mfma_f32_16x16x32_bf16 v[144:147], v[72:75], v[160:163], v[144:147]
    ds_read_b128 v[160:163], v64 offset:8192
    v_cvt_pk_bf16_f32 v120, v140, v141
    v_cvt_pk_bf16_f32 v121, v142, v143
    v_mul_f32 v136, v136, v124
    v_mul_f32 v137, v137, v125
    v_mul_f32 v138, v138, v126
    v_mul_f32 v139, v139, v127
    v_mfma_f32_16x16x16_bf16 v[124:127], v[76:77], v[112:113], 0
    v_mfma_f32_16x16x16_bf16 v[0:3], v[120:121], v[102:103], v[0:3]
    v_mul_f32 v132, v132, v136
    v_mul_f32 v133, v133, v137
    v_mul_f32 v134, v134, v138
    v_mul_f32 v135, v135, v139
    v_mfma_f32_16x16x32_bf16 v[140:143], v[68:71], v[164:167], 0
    ds_read_b128 v[164:167], v64 offset:9216
    v_cvt_pk_bf16_f32 v152, v132, v133
    v_cvt_pk_bf16_f32 v153, v134, v135
    v_mul_f32 v128, v128, v136
    v_mul_f32 v129, v129, v137
    v_mul_f32 v130, v130, v138
    v_mul_f32 v131, v131, v139
    s_waitcnt lgkmcnt(2)
    v_mfma_f32_16x16x32_bf16 v[140:143], v[72:75], v[156:159], v[140:143]
    ds_read_b128 v[156:159], v64 offset:16384
    v_cvt_pk_bf16_f32 v148, v128, v129
    v_cvt_pk_bf16_f32 v149, v130, v131
    v_mfma_f32_16x16x32_bf16 v[32:35], v[150:153], v[100:103], v[32:35]
    v_mul_f32 v124, v124, v136
    v_mul_f32 v125, v125, v137
    v_mul_f32 v126, v126, v138
    v_mul_f32 v127, v127, v139
    v_mfma_f32_16x16x32_bf16 v[48:51], v[148:151], v[106:109], v[48:51]
    v_cvt_pk_bf16_f32 v148, v124, v125
    v_cvt_pk_bf16_f32 v149, v126, v127
    v_mfma_f32_16x16x4_4b_bf16 v[120:135], v[110:111], v[154:155], 0
    ds_read_b64 v[154:155], v64 offset:25600
    s_waitcnt lgkmcnt(3)
    v_mfma_f32_16x16x32_bf16 v[136:139], v[68:71], v[160:163], 0
    ds_read_b128 v[160:163], v64 offset:17408
    v_mfma_f32_16x16x32_bf16 v[16:19], v[148:151], v[102:105], v[16:19]
    s_waitcnt lgkmcnt(3)
    v_mfma_f32_16x16x32_bf16 v[136:139], v[72:75], v[164:167], v[136:139]
    ds_read_b128 v[164:167], v64 offset:12288
    s_cbranch_vccz K2_NOPF2
    buffer_load_dwordx4 v[114:115], s[20:23], 0 idxen offen offset:128 lds
    s_addk_i32 m0, 1024
    s_nop 0
    buffer_load_dwordx4 v[116:117], s[20:23], 0 idxen offen offset:128 lds
    s_addk_i32 m0, 896
K2_NOPF2:
    s_nop 0
    v_mfma_f32_16x16x16_bf16 v[132:135], v[86:87], v[112:113], 0
    s_nop 0
    v_mul_f32 v144, v144, v128
    v_mul_f32 v145, v145, v129
    v_mul_f32 v146, v146, v130
    v_mul_f32 v147, v147, v131
    v_mfma_f32_16x16x16_bf16 v[128:131], v[94:95], v[112:113], 0
    v_cvt_pk_bf16_f32 v150, v144, v145
    v_cvt_pk_bf16_f32 v151, v146, v147
    s_waitcnt lgkmcnt(0)
    v_mfma_f32_16x16x32_bf16 v[144:147], v[68:71], v[156:159], 0
    ds_read_b128 v[156:159], v64 offset:13312
    v_mul_f32 v140, v140, v120
    v_mul_f32 v141, v141, v121
    v_mul_f32 v142, v142, v122
    v_mul_f32 v143, v143, v123
    v_mfma_f32_16x16x32_bf16 v[144:147], v[72:75], v[160:163], v[144:147]
    ds_read_b128 v[160:163], v64 offset:14336
    v_cvt_pk_bf16_f32 v120, v140, v141
    v_cvt_pk_bf16_f32 v121, v142, v143
    v_mul_f32 v136, v136, v124
    v_mul_f32 v137, v137, v125
    v_mul_f32 v138, v138, v126
    v_mul_f32 v139, v139, v127
    v_mfma_f32_16x16x16_bf16 v[124:127], v[78:79], v[112:113], 0
    v_mfma_f32_16x16x16_bf16 v[4:7], v[120:121], v[102:103], v[4:7]
    v_mul_f32 v132, v132, v136
    v_mul_f32 v133, v133, v137
    v_mul_f32 v134, v134, v138
    v_mul_f32 v135, v135, v139
    v_mfma_f32_16x16x32_bf16 v[140:143], v[68:71], v[164:167], 0
    ds_read_b128 v[164:167], v64 offset:15360
    v_cvt_pk_bf16_f32 v152, v132, v133
    v_cvt_pk_bf16_f32 v153, v134, v135
    v_mul_f32 v128, v128, v136
    v_mul_f32 v129, v129, v137
    v_mul_f32 v130, v130, v138
    v_mul_f32 v131, v131, v139
    s_waitcnt lgkmcnt(2)
    v_mfma_f32_16x16x32_bf16 v[140:143], v[72:75], v[156:159], v[140:143]
    ds_read_b128 v[156:159], v64 offset:22528
    v_cvt_pk_bf16_f32 v148, v128, v129
    v_cvt_pk_bf16_f32 v149, v130, v131
    v_mfma_f32_16x16x32_bf16 v[36:39], v[150:153], v[100:103], v[36:39]
    v_mul_f32 v124, v124, v136
    v_mul_f32 v125, v125, v137
    v_mul_f32 v126, v126, v138
    v_mul_f32 v127, v127, v139
    v_mfma_f32_16x16x32_bf16 v[52:55], v[148:151], v[106:109], v[52:55]
    v_cvt_pk_bf16_f32 v148, v124, v125
    v_cvt_pk_bf16_f32 v149, v126, v127
    v_mfma_f32_16x16x4_4b_bf16 v[120:135], v[110:111], v[154:155], 0
    ds_read_b64 v[154:155], v64 offset:25608
    s_waitcnt lgkmcnt(3)
    v_mfma_f32_16x16x32_bf16 v[136:139], v[68:71], v[160:163], 0
    ds_read_b128 v[160:163], v64 offset:23552
    v_mfma_f32_16x16x32_bf16 v[20:23], v[148:151], v[102:105], v[20:23]
    s_waitcnt lgkmcnt(3)
    v_mfma_f32_16x16x32_bf16 v[136:139], v[72:75], v[164:167], v[136:139]
    ds_read_b128 v[164:167], v64 offset:18432
    s_cbranch_vccz K2_NOPF4
    buffer_load_dwordx4 v[114:115], s[20:23], 0 idxen offen offset:256 lds
    s_addk_i32 m0, 1024
    s_nop 0
    buffer_load_dwordx4 v[116:117], s[20:23], 0 idxen offen offset:256 lds
    s_addk_i32 m0, 896
K2_NOPF4:
    s_nop 0
    v_mfma_f32_16x16x16_bf16 v[132:135], v[88:89], v[112:113], 0
    s_nop 0
    v_mul_f32 v144, v144, v128
    v_mul_f32 v145, v145, v129
    v_mul_f32 v146, v146, v130
    v_mul_f32 v147, v147, v131
    v_mfma_f32_16x16x16_bf16 v[128:131], v[96:97], v[112:113], 0
    v_cvt_pk_bf16_f32 v150, v144, v145
    v_cvt_pk_bf16_f32 v151, v146, v147
    s_waitcnt lgkmcnt(0)
    v_mfma_f32_16x16x32_bf16 v[144:147], v[68:71], v[156:159], 0
    ds_read_b128 v[156:159], v64 offset:19456
    v_mul_f32 v140, v140, v120
    v_mul_f32 v141, v141, v121
    v_mul_f32 v142, v142, v122
    v_mul_f32 v143, v143, v123
    v_mfma_f32_16x16x32_bf16 v[144:147], v[72:75], v[160:163], v[144:147]
    ds_read_b128 v[160:163], v64 offset:20480
    v_cvt_pk_bf16_f32 v120, v140, v141
    v_cvt_pk_bf16_f32 v121, v142, v143
    v_mul_f32 v136, v136, v124
    v_mul_f32 v137, v137, v125
    v_mul_f32 v138, v138, v126
    v_mul_f32 v139, v139, v127
    v_mfma_f32_16x16x16_bf16 v[124:127], v[80:81], v[112:113], 0
    v_mfma_f32_16x16x16_bf16 v[8:11], v[120:121], v[102:103], v[8:11]
    v_mul_f32 v132, v132, v136
    v_mul_f32 v133, v133, v137
    v_mul_f32 v134, v134, v138
    v_mul_f32 v135, v135, v139
    v_mfma_f32_16x16x32_bf16 v[140:143], v[68:71], v[164:167], 0
    ds_read_b128 v[164:167], v64 offset:21504
    v_cvt_pk_bf16_f32 v152, v132, v133
    v_cvt_pk_bf16_f32 v153, v134, v135
    v_mul_f32 v128, v128, v136
    v_mul_f32 v129, v129, v137
    v_mul_f32 v130, v130, v138
    v_mul_f32 v131, v131, v139
    s_waitcnt lgkmcnt(2)
    v_mfma_f32_16x16x32_bf16 v[140:143], v[72:75], v[156:159], v[140:143]
    v_cvt_pk_bf16_f32 v148, v128, v129
    v_cvt_pk_bf16_f32 v149, v130, v131
    v_mfma_f32_16x16x32_bf16 v[40:43], v[150:153], v[100:103], v[40:43]
    v_mul_f32 v124, v124, v136
    v_mul_f32 v125, v125, v137
    v_mul_f32 v126, v126, v138
    v_mul_f32 v127, v127, v139
    v_mfma_f32_16x16x32_bf16 v[56:59], v[148:151], v[106:109], v[56:59]
    v_cvt_pk_bf16_f32 v148, v124, v125
    v_cvt_pk_bf16_f32 v149, v126, v127
    v_mfma_f32_16x16x4_4b_bf16 v[120:135], v[110:111], v[154:155], 0
    s_waitcnt lgkmcnt(1)
    v_mfma_f32_16x16x32_bf16 v[136:139], v[68:71], v[160:163], 0
    v_mfma_f32_16x16x32_bf16 v[24:27], v[148:151], v[102:105], v[24:27]
    s_waitcnt lgkmcnt(0)
    v_mfma_f32_16x16x32_bf16 v[136:139], v[72:75], v[164:167], v[136:139]
    s_cbranch_vccz K2_NOPF6
    buffer_load_dwordx4 v[114:115], s[20:23], 0 idxen offen offset:384 lds
    s_addk_i32 m0, 1024
    s_nop 0
    buffer_load_dwordx4 v[116:117], s[20:23], 0 idxen offen offset:384 lds
K2_NOPF6:
    s_nop 3
    v_mfma_f32_16x16x16_bf16 v[132:135], v[90:91], v[112:113], 0
    s_nop 0
    v_mul_f32 v144, v144, v128
    v_mul_f32 v145, v145, v129
    v_mul_f32 v146, v146, v130
    v_mul_f32 v147, v147, v131
    v_mfma_f32_16x16x16_bf16 v[128:131], v[98:99], v[112:113], 0
    v_cvt_pk_bf16_f32 v150, v144, v145
    v_cvt_pk_bf16_f32 v151, v146, v147
    v_mul_f32 v140, v140, v120
    v_mul_f32 v141, v141, v121
    v_mul_f32 v142, v142, v122
    v_mul_f32 v143, v143, v123
    v_cvt_pk_bf16_f32 v120, v140, v141
    v_cvt_pk_bf16_f32 v121, v142, v143
    v_mul_f32 v136, v136, v124
    v_mul_f32 v137, v137, v125
    v_mul_f32 v138, v138, v126
    v_mul_f32 v139, v139, v127
    v_mfma_f32_16x16x16_bf16 v[124:127], v[82:83], v[112:113], 0
    v_mfma_f32_16x16x16_bf16 v[12:15], v[120:121], v[102:103], v[12:15]
    v_mul_f32 v132, v132, v136
    v_mul_f32 v133, v133, v137
    v_mul_f32 v134, v134, v138
    v_mul_f32 v135, v135, v139
    v_cvt_pk_bf16_f32 v152, v132, v133
    v_cvt_pk_bf16_f32 v153, v134, v135
    v_mul_f32 v128, v128, v136
    v_mul_f32 v129, v129, v137
    v_mul_f32 v130, v130, v138
    v_mul_f32 v131, v131, v139
    v_cvt_pk_bf16_f32 v148, v128, v129
    v_cvt_pk_bf16_f32 v149, v130, v131
    v_mfma_f32_16x16x32_bf16 v[44:47], v[150:153], v[100:103], v[44:47]
    v_mul_f32 v124, v124, v136
    v_mul_f32 v125, v125, v137
    v_mul_f32 v126, v126, v138
    v_mul_f32 v127, v127, v139
    v_mfma_f32_16x16x32_bf16 v[60:63], v[148:151], v[106:109], v[60:63]
    v_cvt_pk_bf16_f32 v148, v124, v125
    v_cvt_pk_bf16_f32 v149, v126, v127
    s_nop 1
    v_mfma_f32_16x16x32_bf16 v[28:31], v[148:151], v[102:105], v[28:31]
    s_cmp_lg_u32 s51, 0
    s_cbranch_scc1 K2_HT
K2_NEXT:
    s_add_u32 s47, s47, 768
    s_cmp_ge_u32 s47, s46
    s_cbranch_scc1 K2_EPI
K2_AGAIN:
    s_barrier
    v_lshrrev_b32 v120, 2, v64
    v_mov_b32 v121, 0
    ds_write_b32 v120, v121 offset:47104
    s_cmp_ge_u32 s44, 4
    s_cbranch_scc1 K2_B1
    s_lshl_b32 s3, s44, 16
    s_lshl_b32 s60, s2, 2
    s_add_u32 s3, s3, s60
    v_lshlrev_b32 v120, 6, v64
    buffer_load_dword v124, v120, s[32:35], s3 offen
    s_waitcnt vmcnt(0)
    s_branch K2_A2
K2_EPI:
    s_cmp_gt_u32 s54, 12
    s_cbranch_scc1 K2_END
    v_cvt_pk_bf16_f32 v120, v0, v1
    v_cvt_pk_bf16_f32 v121, v2, v3
    v_cvt_pk_bf16_f32 v122, v4, v5
    v_cvt_pk_bf16_f32 v123, v6, v7
    ds_write_b128 v65, v[120:123] offset:0
    v_cvt_pk_bf16_f32 v124, v8, v9
    v_cvt_pk_bf16_f32 v125, v10, v11
    v_cvt_pk_bf16_f32 v126, v12, v13
    v_cvt_pk_bf16_f32 v127, v14, v15
    ds_write_b128 v66, v[124:127] offset:0
    v_cvt_pk_bf16_f32 v128, v16, v17
    v_cvt_pk_bf16_f32 v129, v18, v19
    v_cvt_pk_bf16_f32 v130, v20, v21
    v_cvt_pk_bf16_f32 v131, v22, v23
    ds_write_b128 v65, v[128:131] offset:2048
    v_cvt_pk_bf16_f32 v132, v24, v25
    v_cvt_pk_bf16_f32 v133, v26, v27
    v_cvt_pk_bf16_f32 v134, v28, v29
    v_cvt_pk_bf16_f32 v135, v30, v31
    ds_write_b128 v66, v[132:135] offset:2048
    v_cvt_pk_bf16_f32 v136, v32, v33
    v_cvt_pk_bf16_f32 v137, v34, v35
    v_cvt_pk_bf16_f32 v138, v36, v37
    v_cvt_pk_bf16_f32 v139, v38, v39
    ds_write_b128 v65, v[136:139] offset:4096
    v_cvt_pk_bf16_f32 v140, v40, v41
    v_cvt_pk_bf16_f32 v141, v42, v43
    v_cvt_pk_bf16_f32 v142, v44, v45
    v_cvt_pk_bf16_f32 v143, v46, v47
    ds_write_b128 v66, v[140:143] offset:4096
    v_cvt_pk_bf16_f32 v144, v48, v49
    v_cvt_pk_bf16_f32 v145, v50, v51
    v_cvt_pk_bf16_f32 v146, v52, v53
    v_cvt_pk_bf16_f32 v147, v54, v55
    ds_write_b128 v65, v[144:147] offset:6144
    v_cvt_pk_bf16_f32 v148, v56, v57
    v_cvt_pk_bf16_f32 v149, v58, v59
    v_cvt_pk_bf16_f32 v150, v60, v61
    v_cvt_pk_bf16_f32 v151, v62, v63
    ds_write_b128 v66, v[148:151] offset:6144
    v_add_u32 v68, s45, v64
    ds_read_b128 v[0:3], v68 offset:0
    ds_read_b128 v[4:7], v68 offset:1024
    ds_read_b128 v[8:11], v68 offset:2048
    ds_read_b128 v[12:15], v68 offset:3072
    ds_read_b128 v[16:19], v68 offset:4096
    ds_read_b128 v[20:23], v68 offset:5120
    ds_read_b128 v[24:27], v68 offset:6144
    ds_read_b128 v[28:31], v68 offset:7168
    v_lshl_add_u32 v160, v118, 7, v115
    v_lshl_add_u32 v161, v118, 7, v117
    v_add_u32 v161, 4096, v161
    s_lshl_b32 s3, s54, 13
    s_waitcnt lgkmcnt(7)
    buffer_store_dwordx4 v[0:3], v160, s[28:31], s3 offen offset:0 sc1
    s_waitcnt lgkmcnt(6)
    buffer_store_dwordx4 v[4:7], v161, s[28:31], s3 offen offset:0 sc1
    s_waitcnt lgkmcnt(5)
    buffer_store_dwordx4 v[8:11], v160, s[28:31], s3 offen offset:128 sc1
    s_waitcnt lgkmcnt(4)
    buffer_store_dwordx4 v[12:15], v161, s[28:31], s3 offen offset:128 sc1
    s_waitcnt lgkmcnt(3)
    buffer_store_dwordx4 v[16:19], v160, s[28:31], s3 offen offset:256 sc1
    s_waitcnt lgkmcnt(2)
    buffer_store_dwordx4 v[20:23], v161, s[28:31], s3 offen offset:256 sc1
    s_waitcnt lgkmcnt(1)
    buffer_store_dwordx4 v[24:27], v160, s[28:31], s3 offen offset:384 sc1
    s_waitcnt lgkmcnt(0)
    buffer_store_dwordx4 v[28:31], v161, s[28:31], s3 offen offset:384 sc1
    s_cmp_lg_u32 s55, 0
    s_cbranch_scc1 K2_FIN
    s_mov_b32 s55, 1
    s_mov_b32 s61, 1
    s_cmp_gt_u32 s46, 768
    s_cbranch_scc1 K2_MULTI
    v_mov_b32 v120, 47364
    v_mov_b32 v121, 1
    s_mov_b64 exec, 1
    ds_add_rtn_u32 v121, v120, v121
    s_mov_b64 exec, -1
    s_waitcnt lgkmcnt(0)
    v_readfirstlane_b32 s3, v121
    s_cmp_lg_u32 s3, 0
    s_cbranch_scc1 K2_FIN
    s_mov_b32 s84, 3
    s_setprio 3
    s_mov_b32 s54, 12
    s_mov_b32 s49, s62
    s_mov_b32 s50, s63
    s_mov_b32 s47, 0
    s_min_u32 s45, s54, 12
    s_lshl_b32 s45, s45, 13
    s_add_u32 s45, s45, 47616
    v_lshlrev_b32 v120, 1, v64
    v_and_b32 v120, 0x40, v120
    v_lshrrev_b32 v121, 1, v64
    v_and_b32 v121, 0x20, v121
    v_or_b32 v120, v120, v121
    v_lshrrev_b32 v121, 4, v64
    v_and_b32 v121, 0x30, v121
    v_xor_b32 v120, v120, v121
    v_lshl_add_u32 v120, v119, 4, v120
    v_add_u32 v65, s45, v120
    v_xor_b32 v66, 64, v65
    s_branch K2_G
K2_MULTI:
    s_cmp_eq_u32 s44, 0
    s_cselect_b32 s54, 12, 15
    s_mov_b32 s47, 0
    s_min_u32 s45, s54, 12
    s_lshl_b32 s45, s45, 13
    s_add_u32 s45, s45, 47616
    v_lshlrev_b32 v120, 1, v64
    v_and_b32 v120, 0x40, v120
    v_lshrrev_b32 v121, 1, v64
    v_and_b32 v121, 0x20, v121
    v_or_b32 v120, v120, v121
    v_lshrrev_b32 v121, 4, v64
    v_and_b32 v121, 0x30, v121
    v_xor_b32 v120, v120, v121
    v_lshl_add_u32 v120, v119, 4, v120
    v_add_u32 v65, s45, v120
    v_xor_b32 v66, 64, v65
    s_branch K2_AGAIN
K2_FIN:
K2_END:
    s_endpgm

.section .rodata,"a"
.p2align 6
.amdhsa_kernel painn_bin_kernel
  .amdhsa_next_free_vgpr 128
  .amdhsa_next_free_sgpr 100
  .amdhsa_accum_offset 128
  .amdhsa_group_segment_fixed_size 0
  .amdhsa_kernarg_size 88
  .amdhsa_user_sgpr_count 2
  .amdhsa_user_sgpr_kernarg_segment_ptr 1
  .amdhsa_system_sgpr_workgroup_id_x 1
  .amdhsa_float_denorm_mode_32 3
.end_amdhsa_kernel
.p2align 6
.amdhsa_kernel painn_msg_kernel
  .amdhsa_next_free_vgpr 168
  .amdhsa_next_free_sgpr 86
  .amdhsa_accum_offset 168
  .amdhsa_group_segment_fixed_size 0
  .amdhsa_kernarg_size 88
  .amdhsa_user_sgpr_count 2
  .amdhsa_user_sgpr_kernarg_segment_ptr 1
  .amdhsa_system_sgpr_workgroup_id_x 1
  .amdhsa_float_denorm_mode_32 3
.end_amdhsa_kernel
```
